```python
import torch

def _softmax(x, axis=-1):
    return torch.softmax(x, dim=axis)
def _gelu(x):
    return torch.nn.functional.gelu(x, approximate="tanh")
def _silu(x):
    return torch.nn.functional.silu(x)
def _sigmoid(x):
    return torch.sigmoid(x)
def _layernorm(x, axis=-1, eps=1e-5):
    m = x.mean(dim=axis, keepdim=True)
    v = x.var(dim=axis, keepdim=True, unbiased=False)
    return (x - m) / torch.sqrt(v + eps)
def _scatter_add(tgt, idx, src, axis=0):
    return tgt.clone().index_add_(axis, idx, src)
def _segment_sum(src, seg, n):
    out = torch.zeros((n,) + src.shape[1:], dtype=src.dtype)
    return out.index_add_(0, seg, src)
def _pad(x, pw):
    flat = tuple(v for pair in reversed(pw) for v in pair)
    return torch.nn.functional.pad(x, flat)

kernel_name = 'gated_mix__grouped_kv_mqa__ssm_conv_h3__prompt'

def setup_inputs():

    _w = (lambda a: (lambda t: t.to(torch.bfloat16) if t.is_floating_point() else t)(torch.as_tensor(a)))
    def _A_setup():
        B, S, D, H = 1, 2048, 576, 32
        Dh = D // H
        return {
            "x": _w((lambda *s: torch.randn(*s, dtype=torch.bfloat16) * 0.05)(B, S, D)),
            "wq": _w((lambda *s: torch.randn(*s, dtype=torch.bfloat16) * 0.8)(D, H * Dh)),
            "wk": _w((lambda *s: torch.randn(*s, dtype=torch.bfloat16) * 0.8)(D, Dh)),
            "wv": _w((lambda *s: torch.randn(*s, dtype=torch.bfloat16) * 0.05)(D, Dh)),
            "wo": _w((lambda *s: torch.randn(*s, dtype=torch.bfloat16) * 0.05)(H * Dh, D)),
        }
    _A_in = _A_setup()

    def _B_setup():
        B, S, D = 1, 2048, 576
        ks = 4
        return {
            "q": _w((lambda *s: torch.randn(*s, dtype=torch.bfloat16) * 0.05)(B, S, D)),
            "k": _w((lambda *s: torch.randn(*s, dtype=torch.bfloat16) * 0.4)(B, S, D)),
            "v": _w((lambda *s: torch.randn(*s, dtype=torch.bfloat16) * 0.2)(B, S, D)),
            "shift_k": _w((lambda *s: torch.randn(*s, dtype=torch.bfloat16) * 0.4)(D, ks) * 0.5),
            "ssm_k": _w((lambda *s: torch.randn(*s, dtype=torch.bfloat16) * 0.4)(D, S) * (1.0 / S ** 0.5)),
            "ssm_D": _w((lambda *s: torch.randn(*s, dtype=torch.bfloat16) * 0.2)(D)),
        }
    _B_in = _B_setup()

    return {
        "A_x": _A_in["x"],
        "A_wq": _A_in["wq"],
        "A_wk": _A_in["wk"],
        "A_wv": _A_in["wv"],
        "A_wo": _A_in["wo"],
        "B_q": _B_in["q"],
        "B_k": _B_in["k"],
        "B_v": _B_in["v"],
        "B_shift_k": _B_in["shift_k"],
        "B_ssm_k": _B_in["ssm_k"],
        "B_ssm_D": _B_in["ssm_D"],
        "gate_w": _w((lambda *s: torch.randn(*s, dtype=torch.bfloat16) * 0.05)(576) * 16.0),
    }

def reference(A_x, A_wq, A_wk, A_wv, A_wo, B_q, B_k, B_v, B_shift_k, B_ssm_k, B_ssm_D, gate_w):
    def _A_ref(x, wq, wk, wv, wo):
        B, S, D = x.shape
        H = 32
        Dh = D // H
        q = (lambda x, *d: x.permute(*d))((x @ wq).reshape(B, S, H, Dh), 0, 2, 1, 3)
        k = x @ wk
        v = x @ wv
        scores = torch.einsum("bhqd,bkd->bhqk", q, k) * (Dh ** -0.5)
        p = _softmax(scores, axis=-1)
        o = torch.einsum("bhqk,bkd->bhqd", p, v)
        return (lambda x, *d: x.permute(*d))(o, 0, 2, 1, 3).reshape(B, S, H * Dh) @ wo

    def _B_ref(q, k, v, shift_k, ssm_k, ssm_D):
        B, S, D = q.shape
        ks = shift_k.shape[-1]
        k_pad = _pad(k, ((0, 0), (ks - 1, 0), (0, 0)))
        k_shift = torch.zeros_like(k)
        for t in range(ks):
            k_shift = k_shift + k_pad[:, t:t + S, :] * shift_k[:, ks - 1 - t][None, None, :]
        kv = k_shift * v
        L = 2 * S
        kv_pad = _pad(kv, ((0, 0), (0, S), (0, 0)))
        kf_pad = _pad(ssm_k, ((0, 0), (0, S)))
        kv_f = (lambda x, axes=(-2,-1): torch.fft.rfft2(x.float(), dim=axes))(kv_pad[:, None, :, :], axes=(1, 2))
        kf_f = (lambda x, axes=(-2,-1): torch.fft.rfft2(x.float(), dim=axes))(kf_pad[:, None, :], axes=(1, 2))
        kf_f = (lambda x, *d: x.permute(*d))(kf_f, 1, 2, 0)
        y_f = kv_f * kf_f[None, :, :, :]
        y = (lambda x, s, axes=(-2,-1): torch.fft.irfft2(x, s=s, dim=axes).to(torch.bfloat16))(y_f, (1, L), axes=(1, 2))[:, 0, :S, :]
        y = y + kv * ssm_D[None, None, :]
        return q * y

    x = A_x
    g = _sigmoid((x * gate_w).sum(-1, keepdims=True))
    a = _A_ref(x, A_wq, A_wk, A_wv, A_wo)
    b = _B_ref(x, B_k, B_v, B_shift_k, B_ssm_k, B_ssm_D)
    return g * a + (1 - g) * b
```

```asm
; @launch grid=(256,1,1) block=(768,1,1) lds=163840
.amdgcn_target "amdgcn-amd-amdhsa--gfx950"
.text
.globl gated_mix__grouped_kv_mqa__ssm_conv_h3__prompt_kernel
.p2align 8
.type gated_mix__grouped_kv_mqa__ssm_conv_h3__prompt_kernel,@function
gated_mix__grouped_kv_mqa__ssm_conv_h3__prompt_kernel:
    s_cmp_ge_u32 s2, 256
    s_cbranch_scc1 L_a_exit
    s_nop 0
    s_load_dwordx8 s[8:15], s[0:1], 0
    s_load_dwordx2 s[36:37], s[0:1], 112
    s_load_dwordx8 s[28:35], s[0:1], 80
    s_load_dwordx2 s[16:17], s[0:1], 32
    s_load_dwordx8 s[20:27], s[0:1], 48
    v_lshrrev_b32_e64 v1, 6, v0
    v_and_b32 v0, 63, v0
    v_readfirstlane_b32 s3, v1
    v_mov_b32 v2, 163328
    v_lshl_add_u32 v4, v0, 2, v2
    v_mov_b32_e64 v5, 0
    ds_write_b32 v4, v5
    ds_write_b32 v4, v5 offset:256
    s_and_b32 s4, s2, 7
    s_lshr_b32 s5, s2, 6
    s_lshl_b32 s5, s5, 3
    s_or_b32 s4, s4, s5
    s_lshr_b32 s5, s2, 3
    s_and_b32 s5, s5, 7
    s_and_b32 s6, s3, 3
    s_lshr_b32 s7, s3, 2
    s_mul_i32 s18, s4, 73728
    s_mul_i32 s19, s5, 144
    v_mov_b32 v3, 2147483392
    v_lshlrev_b32 v1, 4, v0
    s_lshl_b32 s39, s6, 2
    v_add_u32 v19, s39, v2
    v_mov_b32 v18, 1
    s_cmp_eq_u32 s7, 0
    s_cbranch_scc1 L_a_load
    v_lshrrev_b32 v6, 2, v0
    v_lshrrev_b32 v8, 4, v0
    v_sub_u32 v8, 0, v8
    v_xor_b32 v8, v8, v0
    v_and_b32 v8, 3, v8
    v_lshlrev_b32 v8, 4, v8
    v_mul_u32_u24 v6, 1152, v6
    v_add_u32_e64 v6, v6, v8
    s_mul_i32 s61, s6, 18432
    s_add_u32 s60, s61, s18
    s_and_b32 s62, s7, 1
    s_mul_i32 s63, s62, 576
    s_add_u32 s60, s60, s63
    s_nop 0
    s_mul_i32 s63, s62, 9216
    s_add_u32 s61, s61, s63
    s_mov_b32 s62, 9
    s_waitcnt lgkmcnt(0)
    s_mov_b32 s48, s8
    s_and_b32 s49, s9, 0xffff
    s_mov_b32 s50, 2359296
    s_mov_b32 s51, 0x00020000
L_a_xl:
    s_mov_b32 m0, s61
    s_nop 0
    s_add_u32 s61, s61, 1024
    buffer_load_dwordx4 v6, s[48:51], s60 offen lds
    s_add_u32 s60, s60, 64
    s_sub_u32 s62, s62, 1
    s_cmp_lg_u32 s62, 0
    s_cbranch_scc1 L_a_xl
    s_cmp_eq_u32 s7, 2
    s_cbranch_scc1 L_a_helper
    s_branch L_a_cons
L_a_load:
    s_cmp_ge_u32 s5, 3
    s_cselect_b32 s61, 3, 0
    s_sub_u32 s60, s5, s61
    s_lshl_b32 s61, s60, 4
    s_cmp_eq_u32 s60, 2
    s_cselect_b32 s61, 20, s61
    v_mul_u32_u24 v13, 36, v0
    v_add_u32_e64 v13, s61, v13
    s_mul_i32 s62, s6, 2304
    s_lshl_b32 s63, s6, 10
    s_nop 0
    s_add_u32 s63, s63, 154112
    s_waitcnt lgkmcnt(0)
    s_cmp_lt_u32 s5, 3
    s_cselect_b32 s52, s12, s14
    s_cselect_b32 s53, s13, s15
    s_and_b32 s53, s53, 0xffff
    s_mov_b32 s54, 20736
    s_mov_b32 s55, 0x00020000
    s_cmp_lt_u32 s5, 6
    s_cbranch_scc0 L_a_lnw
    s_mov_b32 m0, s63
    s_nop 0
    s_add_u32 s63, s63, 4096
    buffer_load_dwordx4 v13, s[52:55], s62 offen lds
    s_add_u32 s62, s62, 9216
    s_mov_b32 m0, s63
    s_nop 0
    s_add_u32 s63, s63, 4096
    buffer_load_dwordx4 v13, s[52:55], s62 offen lds
    s_add_u32 s62, s62, 9216
    s_cmp_eq_u32 s6, 0
    s_cbranch_scc0 L_a_lnw
    s_mov_b32 m0, s63
    s_add_u32 s63, s63, 0
    buffer_load_dwordx4 v13, s[52:55], s62 offen lds
    s_add_u32 s62, s62, 0
L_a_lnw:
    s_mov_b32 s40, s36
    s_and_b32 s41, s37, 0xffff
    s_mov_b32 s42, 16777216
    s_mov_b32 s43, 0x00020000
    s_mov_b32 s56, s34
    s_nop 0
    s_and_b32 s57, s35, 0xffff
    s_mov_b32 s58, 256
    s_mov_b32 s59, 0x00020000
    s_lshl_b32 s64, s2, 2
    s_add_u32 s64, s64, s6
    v_mov_b32_e64 v21, v3
    s_cmp_eq_u32 s64, 227
    s_cbranch_scc0 L_a_noclr
    v_lshlrev_b32 v20, 7, v0
    s_mov_b32 s64, 196608
    v_mov_b32 v24, 0
    v_mov_b32 v25, 0
    v_mov_b32 v26, 0
    v_mov_b32 v27, 0
    buffer_store_dwordx4 v[24:27], v20, s[40:43], s64 offen sc1
    buffer_store_dwordx4 v[24:27], v20, s[40:43], s64 offen offset:16 sc1
    s_add_u32 s64, s64, 8192
    buffer_store_dwordx4 v[24:27], v20, s[40:43], s64 offen sc1
    buffer_store_dwordx4 v[24:27], v20, s[40:43], s64 offen offset:16 sc1
    v_cmp_eq_u32 vcc, 0, v0
    s_nop 1
    v_cndmask_b32 v21, v3, v24, vcc
L_a_noclr:
    s_lshl_b32 s60, s6, 6
    v_add_u32_e64 v10, s60, v0
    v_mul_u32_u24 v11, 7282, v10
    v_lshrrev_b32 v11, 16, v11
    v_mul_u32_u24 v7, 9, v11
    v_sub_u32 v10, v10, v7
    v_lshlrev_b32 v10, 4, v10
    v_and_b32 v7, 56, v11
    v_and_b32 v12, 1, v11
    v_lshl_add_u32 v7, v12, 2, v7
    v_bfe_u32 v12, v11, 1, 2
    v_add_u32_e64 v7, v7, v12
    v_mul_u32_u24 v7, 1152, v7
    v_add3_u32 v7, v7, v10, s19
    s_add_u32 s61, s6, 4
    s_lshl_b32 s60, s61, 6
    v_add_u32_e64 v10, s60, v0
    v_mul_u32_u24 v11, 7282, v10
    v_lshrrev_b32 v11, 16, v11
    v_mul_u32_u24 v8, 9, v11
    v_sub_u32 v10, v10, v8
    v_lshlrev_b32 v10, 4, v10
    v_and_b32 v8, 56, v11
    v_and_b32 v12, 1, v11
    v_lshl_add_u32 v8, v12, 2, v8
    v_bfe_u32 v12, v11, 1, 2
    v_add_u32_e64 v8, v8, v12
    v_mul_u32_u24 v8, 1152, v8
    v_add3_u32 v8, v8, v10, s19
    s_lshl_b32 s60, 8, 6
    v_add_u32 v10, s60, v0
    v_mul_u32_u24 v11, 7282, v10
    v_lshrrev_b32 v11, 16, v11
    v_mul_u32_u24 v9, 9, v11
    v_sub_u32 v10, v10, v9
    v_lshlrev_b32 v10, 4, v10
    v_and_b32 v9, 56, v11
    v_and_b32 v12, 1, v11
    v_lshl_add_u32 v9, v12, 2, v9
    v_bfe_u32 v12, v11, 1, 2
    v_add_u32_e64 v9, v9, v12
    v_mul_u32_u24 v9, 1152, v9
    v_add3_u32 v9, v9, v10, s19
    s_lshl_b32 s62, s6, 10
    s_nop 0
    s_add_u32 s62, s62, 73728
    s_cmp_eq_u32 s6, 3
    s_cselect_b32 s63, 0, s6
    s_barrier
    s_waitcnt vmcnt(0)
    ds_write_b32 v19, v18 offset:192
    s_cmp_eq_u32 s2, 56
    s_cbranch_scc0 L_a_noclr2
    buffer_store_dword v18, v21, s[56:59], 0 offen sc1
L_a_noclr2:
    s_mov_b32 s48, s10
    s_nop 0
    s_and_b32 s49, s11, 0xffff
    s_mov_b32 s50, 663552
    s_mov_b32 s51, 0x00020000
    s_add_u32 s60, s62, 0
    s_mov_b32 m0, s60
    s_mov_b32 s61, 0
    s_nop 0
    buffer_load_dwordx4 v7, s[48:51], s61 offen lds
    s_add_u32 s60, s62, 4096
    s_mov_b32 m0, s60
    s_mov_b32 s61, 0
    buffer_load_dwordx4 v8, s[48:51], s61 offen lds
    s_add_u32 s60, s62, 9216
    s_mov_b32 m0, s60
    s_nop 0
    s_mov_b32 s61, 73728
    buffer_load_dwordx4 v7, s[48:51], s61 offen lds
    s_add_u32 s60, s62, 13312
    s_mov_b32 m0, s60
    s_nop 0
    s_mov_b32 s61, 73728
    buffer_load_dwordx4 v8, s[48:51], s61 offen lds
    s_add_u32 s60, s62, 18432
    s_mov_b32 m0, s60
    s_nop 0
    s_mov_b32 s61, 147456
    buffer_load_dwordx4 v7, s[48:51], s61 offen lds
    s_waitcnt vmcnt(4)
    s_nop 0
    s_add_u32 s60, s62, 22528
    s_mov_b32 m0, s60
    s_nop 0
    s_mov_b32 s61, 147456
    buffer_load_dwordx4 v8, s[48:51], s61 offen lds
    s_waitcnt vmcnt(4)
    s_add_u32 s61, s63, 0
    s_mul_i32 s60, s61, 9216
    s_add_u32 s60, s60, 81920
    s_mov_b32 m0, s60
    s_nop 0
    s_mul_i32 s61, s61, 73728
    buffer_load_dwordx4 v9, s[48:51], s61 offen lds
    s_waitcnt vmcnt(4)
    s_nop 0
    s_add_u32 s60, s62, 27648
    s_mov_b32 m0, s60
    s_nop 0
    s_mov_b32 s61, 221184
    buffer_load_dwordx4 v7, s[48:51], s61 offen lds
    s_waitcnt vmcnt(4)
    s_nop 0
    s_add_u32 s60, s62, 31744
    s_mov_b32 m0, s60
    s_nop 0
    s_mov_b32 s61, 221184
    buffer_load_dwordx4 v8, s[48:51], s61 offen lds
    s_waitcnt vmcnt(4)
    s_nop 0
    s_add_u32 s60, s62, 36864
    s_mov_b32 m0, s60
    s_nop 0
    s_mov_b32 s61, 294912
    buffer_load_dwordx4 v7, s[48:51], s61 offen lds
    s_waitcnt vmcnt(4)
    s_nop 0
    s_add_u32 s60, s62, 40960
    s_mov_b32 m0, s60
    s_nop 0
    s_mov_b32 s61, 294912
    buffer_load_dwordx4 v8, s[48:51], s61 offen lds
    s_waitcnt vmcnt(4)
    s_nop 0
    ds_write_b32 v19, v18 offset:0
    s_add_u32 s60, s62, 46080
    s_mov_b32 m0, s60
    s_nop 0
    s_mov_b32 s61, 368640
    buffer_load_dwordx4 v7, s[48:51], s61 offen lds
    s_waitcnt vmcnt(4)
    s_nop 0
    s_add_u32 s60, s62, 50176
    s_mov_b32 m0, s60
    s_nop 0
    s_mov_b32 s61, 368640
    buffer_load_dwordx4 v8, s[48:51], s61 offen lds
    s_waitcnt vmcnt(4)
    s_add_u32 s61, s63, 3
    s_mul_i32 s60, s61, 9216
    s_add_u32 s60, s60, 81920
    s_mov_b32 m0, s60
    s_nop 0
    s_mul_i32 s61, s61, 73728
    buffer_load_dwordx4 v9, s[48:51], s61 offen lds
    s_waitcnt vmcnt(4)
    s_nop 0
    s_add_u32 s60, s62, 55296
    s_mov_b32 m0, s60
    s_nop 0
    s_mov_b32 s61, 442368
    buffer_load_dwordx4 v7, s[48:51], s61 offen lds
    s_waitcnt vmcnt(4)
    s_nop 0
    s_add_u32 s60, s62, 59392
    s_mov_b32 m0, s60
    s_nop 0
    s_mov_b32 s61, 442368
    buffer_load_dwordx4 v8, s[48:51], s61 offen lds
    s_waitcnt vmcnt(4)
    s_nop 0
    s_add_u32 s60, s62, 64512
    s_mov_b32 m0, s60
    s_nop 0
    s_mov_b32 s61, 516096
    buffer_load_dwordx4 v7, s[48:51], s61 offen lds
    s_waitcnt vmcnt(4)
    s_nop 0
    s_add_u32 s60, s62, 68608
    s_mov_b32 m0, s60
    s_nop 0
    s_mov_b32 s61, 516096
    buffer_load_dwordx4 v8, s[48:51], s61 offen lds
    s_waitcnt vmcnt(4)
    s_nop 0
    ds_write_b32 v19, v18 offset:16
    s_mov_b32 s66, 160000
L_lw1:
    ds_read_b128 v[32:35], v2 offset:64
    s_waitcnt lgkmcnt(0)
    v_min_u32 v32, v32, v33
    v_min3_u32 v32, v32, v34, v35
    v_cmp_gt_u32 vcc, 1, v32
    s_cbranch_vccz L_lw1_ok
    s_sleep 1
    s_sub_u32 s66, s66, 1
    s_cmp_lg_u32 s66, 0
    s_cbranch_scc1 L_lw1
L_lw1_ok:
    s_add_u32 s60, s62, 73728
    s_mov_b32 m0, s60
    s_nop 0
    s_mov_b32 s61, 589824
    buffer_load_dwordx4 v7, s[48:51], s61 offen lds
    s_waitcnt vmcnt(4)
    s_nop 0
    s_add_u32 s60, s62, 77824
    s_mov_b32 m0, s60
    s_nop 0
    s_mov_b32 s61, 589824
    buffer_load_dwordx4 v8, s[48:51], s61 offen lds
    s_waitcnt vmcnt(4)
    s_add_u32 s61, s63, 6
    s_mul_i32 s60, s61, 9216
    s_add_u32 s60, s60, 81920
    s_mov_b32 m0, s60
    s_nop 0
    s_mul_i32 s61, s61, 73728
    buffer_load_dwordx4 v9, s[48:51], s61 offen lds
    s_waitcnt vmcnt(4)
    s_waitcnt vmcnt(0)
    ds_write_b32 v19, v18 offset:32
    v_mov_b32 v148, v3
    v_mov_b32 v149, v3
    v_mov_b32 v150, v3
    v_mov_b32 v151, v3
    v_mov_b32 v152, v3
    v_mov_b32 v153, v3
    v_mov_b32 v159, v3
    v_mov_b32 v160, v3
    v_mov_b32 v161, v3
    v_mov_b32 v162, v3
    v_mov_b32_e64 v163, v3
    s_cmp_eq_u32 s6, 0
    s_cbranch_scc0 L_a_kvok
    s_mov_b32 s66, 160000
L_lw2:
    ds_read_b128 v[32:35], v2 offset:32
    s_waitcnt lgkmcnt(0)
    v_min_u32 v32, v32, v33
    v_min3_u32 v32, v32, v34, v35
    v_cmp_gt_u32 vcc, 1, v32
    s_cbranch_vccz L_lw2_ok
    s_sleep 1
    s_sub_u32 s66, s66, 1
    s_cmp_lg_u32 s66, 0
    s_cbranch_scc1 L_lw2
L_lw2_ok:
    s_mov_b32 s66, 160000
L_lw3:
    ds_read_b32 v32, v2 offset:496
    s_waitcnt lgkmcnt(0)
    v_cmp_gt_u32 vcc, 1, v32
    s_cbranch_vccz L_lw3_ok
    s_sleep 1
    s_sub_u32 s66, s66, 1
    s_cmp_lg_u32 s66, 0
    s_cbranch_scc1 L_lw3
L_lw3_ok:
    v_lshrrev_b32 v18, 1, v0
    v_lshlrev_b32 v18, 7, v18
    v_and_b32 v20, 1, v0
    v_lshl_add_u32 v18, v20, 4, v18
    s_mov_b32 s60, 196608
    s_mov_b32 s66, 20000
    s_sleep 0
L_a_kvpoll:
    s_nop 0
    buffer_load_dwordx4 v[20:23], v18, s[40:43], s60 offen sc1
    s_waitcnt vmcnt(0)
    v_min_u32 v24, v20, v21
    v_min3_u32 v24, v24, v22, v23
    v_cmp_eq_u32 vcc, 0, v24
    s_cbranch_vccz L_a_kvok2
    s_sleep 2
    s_sub_u32 s66, s66, 1
    s_cmp_lg_u32 s66, 0
    s_cbranch_scc1 L_a_kvpoll
L_a_kvok2:
    v_max_u32_e64 v25, v20, v21
    v_max3_u32 v25, v25, v22, v23
    s_lshl_b32 s60, s4, 1
    s_add_u32 s61, s60, 1
    v_readlane_b32 s62, v24, s60
    v_readlane_b32 s63, v24, s61
    v_readlane_b32 s64, v25, s60
    v_readlane_b32 s65, v25, s61
    s_min_u32 s62, s62, s63
    s_max_u32 s64, s64, s65
    s_cmp_eq_u32 s62, s64
    s_cselect_b32 s62, 1, 0
    v_mov_b32_e64 v20, s62
    ds_write_b32 v2, v20 offset:416
L_a_kvok:
    s_branch L_a_b3a
L_a_cons:
    s_mov_b32 s60, 0
    v_lshrrev_b32 v10, 4, v0
    v_lshlrev_b32 v10, 3, v10
    v_bfe_u32 v11, v0, 2, 2
    v_lshl_add_u32 v10, v11, 1, v10
    v_mul_u32_u24 v10, 144, v10
    v_and_b32_e64 v11, 3, v0
    v_lshl_add_u32 v10, v11, 3, v10
    v_add_u32 v10, 73728, v10
    v_add_u32_e64 v14, s60, v10
    v_add_u32 v15, 41472, v14
    v_and_b32 v10, 15, v0
    v_lshrrev_b32 v11, 2, v10
    v_sub_u32 v11, 0, v11
    v_lshrrev_b32 v12, 4, v0
    v_xor_b32 v11, v11, v12
    v_and_b32 v11, 3, v11
    v_lshlrev_b32_e64 v11, 4, v11
    v_lshl_add_u32 v16, v10, 6, v11
    s_mul_i32 s60, s6, 18432
    v_add_u32 v16, s60, v16
    v_lshlrev_b32 v12, 2, v12
    s_waitcnt lgkmcnt(0)
    s_mov_b32 s40, s36
    s_and_b32 s41, s37, 0xffff
    s_mov_b32 s42, 16777216
    s_mov_b32 s43, 0x00020000
    s_barrier
    s_lshl_b32 s62, s6, 6
    v_add_u32_e64 v96, s62, v0
    v_mul_u32_u24 v97, 7282, v96
    v_lshrrev_b32 v97, 16, v97
    v_mul_u32_u24 v98, 9, v97
    v_sub_u32 v96, v96, v98
    v_lshlrev_b32 v96, 4, v96
    v_lshrrev_b32 v98, 4, v97
    v_mul_u32_u24 v98, 18, v98
    v_bfe_u32 v99, v97, 3, 1
    v_lshl_add_u32 v98, v99, 2, v98
    v_and_b32_e64 v99, 1, v97
    v_lshl_add_u32 v98, v99, 3, v98
    v_bfe_u32 v100, v97, 1, 2
    v_add_u32_e64 v98, v98, v100
    v_mul_u32_u24 v98, 1152, v98
    v_add3_u32 v148, v98, v96, s19
    v_lshrrev_b32 v98, 3, v97
    v_lshlrev_b32 v98, 2, v98
    v_lshl_add_u32 v98, v99, 1, v98
    v_lshrrev_b32 v99, 1, v100
    v_add_u32 v98, v98, v99
    v_mul_u32_u24 v98, 18, v98
    v_and_b32 v100, 1, v100
    v_add3_u32 v98, v98, v100, 16
    v_mul_u32_u24 v98, 1152, v98
    v_add3_u32 v151, v98, v96, s19
    s_add_u32 s61, s6, 4
    s_lshl_b32 s62, s61, 6
    v_add_u32_e64 v96, s62, v0
    v_mul_u32_u24 v97, 7282, v96
    v_lshrrev_b32 v97, 16, v97
    v_mul_u32_u24 v98, 9, v97
    v_sub_u32 v96, v96, v98
    v_lshlrev_b32 v96, 4, v96
    v_lshrrev_b32 v98, 4, v97
    v_mul_u32_u24 v98, 18, v98
    v_bfe_u32 v99, v97, 3, 1
    v_lshl_add_u32 v98, v99, 2, v98
    v_and_b32_e64 v99, 1, v97
    v_lshl_add_u32 v98, v99, 3, v98
    v_bfe_u32 v100, v97, 1, 2
    v_add_u32_e64 v98, v98, v100
    v_mul_u32_u24 v98, 1152, v98
    v_add3_u32 v149, v98, v96, s19
    v_lshrrev_b32 v98, 3, v97
    v_lshlrev_b32 v98, 2, v98
    v_lshl_add_u32 v98, v99, 1, v98
    v_lshrrev_b32 v99, 1, v100
    v_add_u32 v98, v98, v99
    v_mul_u32_u24 v98, 18, v98
    v_and_b32 v100, 1, v100
    v_add3_u32 v98, v98, v100, 16
    v_mul_u32_u24 v98, 1152, v98
    v_add3_u32 v152, v98, v96, s19
    s_lshl_b32 s62, 8, 6
    v_add_u32 v96, s62, v0
    v_mul_u32_u24 v97, 7282, v96
    v_lshrrev_b32 v97, 16, v97
    v_mul_u32_u24 v98, 9, v97
    v_sub_u32 v96, v96, v98
    v_lshlrev_b32 v96, 4, v96
    v_lshrrev_b32 v98, 4, v97
    v_mul_u32_u24 v98, 18, v98
    v_bfe_u32 v99, v97, 3, 1
    v_lshl_add_u32 v98, v99, 2, v98
    v_and_b32_e64 v99, 1, v97
    v_lshl_add_u32 v98, v99, 3, v98
    v_bfe_u32 v100, v97, 1, 2
    v_add_u32_e64 v98, v98, v100
    v_mul_u32_u24 v98, 1152, v98
    v_add3_u32 v150, v98, v96, s19
    v_lshrrev_b32 v98, 3, v97
    v_lshlrev_b32 v98, 2, v98
    v_lshl_add_u32 v98, v99, 1, v98
    v_lshrrev_b32 v99, 1, v100
    v_add_u32 v98, v98, v99
    v_mul_u32_u24 v98, 18, v98
    v_and_b32 v100, 1, v100
    v_add3_u32 v98, v98, v100, 16
    v_mul_u32_u24 v98, 1152, v98
    v_add3_u32 v153, v98, v96, s19
    s_mul_i32 s75, s6, 6144
    s_add_u32 s75, s75, 24576
    v_add_u32_e64 v96, 0, v0
    v_mul_u32_u24 v97, 7282, v96
    v_lshrrev_b32 v97, 16, v97
    v_mul_u32_u24 v98, 9, v97
    v_sub_u32 v98, v96, v98
    v_lshlrev_b32 v98, 4, v98
    v_cmp_gt_u32 vcc, 144, v96
    v_mul_u32_u24 v97, 1152, v97
    v_add3_u32 v159, v97, v98, s19
    v_cndmask_b32 v159, v3, v159, vcc
    v_add_u32 v96, 64, v0
    v_mul_u32_u24 v97, 7282, v96
    v_lshrrev_b32 v97, 16, v97
    v_mul_u32_u24 v98, 9, v97
    v_sub_u32 v98, v96, v98
    v_lshlrev_b32 v98, 4, v98
    v_cmp_gt_u32 vcc, 144, v96
    v_mul_u32_u24 v97, 1152, v97
    v_add3_u32 v160, v97, v98, s19
    v_cndmask_b32 v160, v3, v160, vcc
    s_nop 0
    v_add_u32 v96, 128, v0
    v_mul_u32_u24 v97, 7282, v96
    v_lshrrev_b32 v97, 16, v97
    v_mul_u32_u24 v98, 9, v97
    v_sub_u32 v98, v96, v98
    v_lshlrev_b32 v98, 4, v98
    v_cmp_gt_u32 vcc, 144, v96
    v_mul_u32_u24 v97, 1152, v97
    v_add3_u32 v161, v97, v98, s19
    v_cndmask_b32 v161, v3, v161, vcc
    v_and_b32 v96, 15, v0
    v_lshrrev_b32 v98, 4, v0
    v_lshlrev_b32 v98, 3, v98
    v_mul_u32_u24 v165, 144, v96
    v_add3_u32 v165, v165, v98, s75
    v_mul_u32_u24 v162, 1152, v96
    v_add3_u32 v162, v162, v98, s19
    v_lshlrev_b32 v166, 3, v0
    v_add_u32 v166, s75, v166
    v_add_u32_e64 v167, s75, v1
    v_lshlrev_b32 v163, 2, v96
    s_waitcnt vmcnt(0)
    ds_write_b32 v19, v18 offset:240
    s_add_u32 s60, s60, 15360
    v_add_u32_e64 v9, 0, v12
    v_mul_u32_u24 v11, 3641, v9
    v_lshrrev_b32 v11, 16, v11
    v_mul_u32_u24 v13, 18, v11
    v_sub_u32_e64 v13, v9, v13
    v_mul_u32_u24 v11, 576, v11
    v_lshrrev_b32_e64 v9, 3, v13
    v_lshl_add_u32 v9, v9, 4, v10
    v_lshlrev_b32 v9, 4, v9
    v_and_b32 v84, 7, v13
    v_lshl_add_u32 v9, v84, 1, v9
    v_cmp_gt_u32 vcc, 16, v13
    v_lshlrev_b32 v84, 2, v10
    v_add_u32 v84, 512, v84
    v_cndmask_b32 v84, v84, v9, vcc
    s_nop 0
    v_add3_u32 v84, v84, v11, s60
    v_add_u32_e64 v9, 2, v12
    v_mul_u32_u24 v11, 3641, v9
    v_lshrrev_b32 v11, 16, v11
    v_mul_u32_u24 v13, 18, v11
    v_sub_u32_e64 v13, v9, v13
    v_mul_u32_u24 v11, 576, v11
    v_lshrrev_b32_e64 v9, 3, v13
    v_lshl_add_u32 v9, v9, 4, v10
    v_lshlrev_b32 v9, 4, v9
    v_and_b32 v85, 7, v13
    v_lshl_add_u32 v9, v85, 1, v9
    v_cmp_gt_u32 vcc, 16, v13
    v_lshlrev_b32 v85, 2, v10
    v_add_u32 v85, 512, v85
    v_cndmask_b32 v85, v85, v9, vcc
    s_nop 0
    v_add3_u32 v85, v85, v11, s60
    v_add_u32_e64 v9, 16, v12
    v_mul_u32_u24 v11, 3641, v9
    v_lshrrev_b32 v11, 16, v11
    v_mul_u32_u24 v13, 18, v11
    v_sub_u32_e64 v13, v9, v13
    v_mul_u32_u24 v11, 576, v11
    v_lshrrev_b32_e64 v9, 3, v13
    v_lshl_add_u32 v9, v9, 4, v10
    v_lshlrev_b32 v9, 4, v9
    v_and_b32 v86, 7, v13
    v_lshl_add_u32 v9, v86, 1, v9
    v_cmp_gt_u32 vcc, 16, v13
    v_lshlrev_b32 v86, 2, v10
    v_add_u32 v86, 512, v86
    v_cndmask_b32 v86, v86, v9, vcc
    s_nop 0
    v_add3_u32 v86, v86, v11, s60
    v_add_u32_e64 v9, 18, v12
    v_mul_u32_u24 v11, 3641, v9
    v_lshrrev_b32 v11, 16, v11
    v_mul_u32_u24 v13, 18, v11
    v_sub_u32_e64 v13, v9, v13
    v_mul_u32_u24 v11, 576, v11
    v_lshrrev_b32_e64 v9, 3, v13
    v_lshl_add_u32 v9, v9, 4, v10
    v_lshlrev_b32 v9, 4, v9
    v_and_b32 v87, 7, v13
    v_lshl_add_u32 v9, v87, 1, v9
    v_cmp_gt_u32 vcc, 16, v13
    v_lshlrev_b32 v87, 2, v10
    v_add_u32 v87, 512, v87
    v_cndmask_b32 v87, v87, v9, vcc
    s_nop 0
    v_add3_u32 v87, v87, v11, s60
    v_add_u32_e64 v9, 32, v12
    v_mul_u32_u24 v11, 3641, v9
    v_lshrrev_b32 v11, 16, v11
    v_mul_u32_u24 v13, 18, v11
    v_sub_u32_e64 v13, v9, v13
    v_mul_u32_u24 v11, 576, v11
    v_lshrrev_b32_e64 v9, 3, v13
    v_lshl_add_u32 v9, v9, 4, v10
    v_lshlrev_b32 v9, 4, v9
    v_and_b32 v88, 7, v13
    v_lshl_add_u32 v9, v88, 1, v9
    v_cmp_gt_u32 vcc, 16, v13
    v_lshlrev_b32 v88, 2, v10
    v_add_u32 v88, 512, v88
    v_cndmask_b32 v88, v88, v9, vcc
    s_nop 0
    v_add3_u32 v88, v88, v11, s60
    v_add_u32_e64 v9, 34, v12
    v_mul_u32_u24 v11, 3641, v9
    v_lshrrev_b32 v11, 16, v11
    v_mul_u32_u24 v13, 18, v11
    v_sub_u32_e64 v13, v9, v13
    v_mul_u32_u24 v11, 576, v11
    v_lshrrev_b32_e64 v9, 3, v13
    v_lshl_add_u32 v9, v9, 4, v10
    v_lshlrev_b32 v9, 4, v9
    v_and_b32 v89, 7, v13
    v_lshl_add_u32 v9, v89, 1, v9
    v_cmp_gt_u32 vcc, 16, v13
    v_lshlrev_b32 v89, 2, v10
    v_add_u32 v89, 512, v89
    v_cndmask_b32 v89, v89, v9, vcc
    s_nop 0
    v_add3_u32 v89, v89, v11, s60
    v_add_u32_e64 v9, 48, v12
    v_mul_u32_u24 v11, 3641, v9
    v_lshrrev_b32 v11, 16, v11
    v_mul_u32_u24 v13, 18, v11
    v_sub_u32_e64 v13, v9, v13
    v_mul_u32_u24 v11, 576, v11
    v_lshrrev_b32_e64 v9, 3, v13
    v_lshl_add_u32 v9, v9, 4, v10
    v_lshlrev_b32 v9, 4, v9
    v_and_b32 v90, 7, v13
    v_lshl_add_u32 v9, v90, 1, v9
    v_cmp_gt_u32 vcc, 16, v13
    v_lshlrev_b32 v90, 2, v10
    v_add_u32 v90, 512, v90
    v_cndmask_b32 v90, v90, v9, vcc
    s_nop 0
    v_add3_u32 v90, v90, v11, s60
    v_add_u32_e64 v9, 50, v12
    v_mul_u32_u24 v11, 3641, v9
    v_lshrrev_b32 v11, 16, v11
    v_mul_u32_u24 v13, 18, v11
    v_sub_u32_e64 v13, v9, v13
    v_mul_u32_u24 v11, 576, v11
    v_lshrrev_b32_e64 v9, 3, v13
    v_lshl_add_u32 v9, v9, 4, v10
    v_lshlrev_b32 v9, 4, v9
    v_and_b32 v91, 7, v13
    v_lshl_add_u32 v9, v91, 1, v9
    v_cmp_gt_u32 vcc, 16, v13
    v_lshlrev_b32 v91, 2, v10
    v_add_u32 v91, 512, v91
    v_cndmask_b32 v91, v91, v9, vcc
    s_nop 0
    v_add3_u32 v91, v91, v11, s60
    v_add_u32_e64 v9, 64, v12
    v_mul_u32_u24 v11, 3641, v9
    v_lshrrev_b32 v11, 16, v11
    v_mul_u32_u24 v13, 18, v11
    v_sub_u32_e64 v13, v9, v13
    v_mul_u32_u24 v11, 576, v11
    v_lshrrev_b32_e64 v9, 3, v13
    v_lshl_add_u32 v9, v9, 4, v10
    v_lshlrev_b32 v9, 4, v9
    v_and_b32 v92, 7, v13
    v_lshl_add_u32 v9, v92, 1, v9
    v_cmp_gt_u32 vcc, 16, v13
    v_lshlrev_b32 v92, 2, v10
    v_add_u32 v92, 512, v92
    v_cndmask_b32 v92, v92, v9, vcc
    s_nop 0
    v_add3_u32 v92, v92, v11, s60
    v_add_u32 v9, 66, v12
    v_mul_u32_u24 v11, 3641, v9
    v_lshrrev_b32 v11, 16, v11
    v_mul_u32_u24 v13, 18, v11
    v_sub_u32_e64 v13, v9, v13
    v_mul_u32_u24 v11, 576, v11
    v_lshrrev_b32_e64 v9, 3, v13
    v_lshl_add_u32 v9, v9, 4, v10
    v_lshlrev_b32 v9, 4, v9
    v_and_b32 v93, 7, v13
    v_lshl_add_u32 v9, v93, 1, v9
    v_cmp_gt_u32 vcc, 16, v13
    v_lshlrev_b32 v93, 2, v10
    v_add_u32 v93, 512, v93
    v_cndmask_b32 v93, v93, v9, vcc
    s_nop 0
    v_add3_u32 v93, v93, v11, s60
    s_mov_b32 s66, 160000
L_lw4:
    ds_read_b32 v4, v19 offset:48
    s_waitcnt lgkmcnt(0)
    v_cmp_gt_u32 vcc, 1, v4
    s_cbranch_vccz L_lw4_ok
    s_sleep 1
    s_sub_u32 s66, s66, 1
    s_cmp_lg_u32 s66, 0
    s_cbranch_scc1 L_lw4
L_lw4_ok:
    s_nop 0
    s_mov_b32 s66, 160000
L_lw5:
    ds_read_b128 v[4:7], v2 offset:0
    s_waitcnt lgkmcnt(0)
    v_min_u32 v4, v4, v5
    v_min3_u32 v4, v4, v6, v7
    v_cmp_gt_u32 vcc, 1, v4
    s_cbranch_vccz L_lw5_ok
    s_sleep 1
    s_sub_u32 s66, s66, 1
    s_cmp_lg_u32 s66, 0
    s_cbranch_scc1 L_lw5
L_lw5_ok:
    ds_read_b128 v[20:23], v16 offset:0
    ds_read_b64_tr_b16 v[32:33], v14 offset:0
    ds_read_b64_tr_b16 v[34:35], v14 offset:144
    ds_read_b64_tr_b16 v[36:37], v14 offset:32
    ds_read_b64_tr_b16 v[38:39], v14 offset:176
    ds_read_b64_tr_b16 v[40:41], v14 offset:64
    ds_read_b64_tr_b16 v[42:43], v14 offset:208
    ds_read_b64_tr_b16 v[44:45], v14 offset:96
    ds_read_b64_tr_b16 v[46:47], v14 offset:240
    ds_read_b64_tr_b16 v[48:49], v14 offset:128
    ds_read_b64_tr_b16 v[50:51], v14 offset:272
    ds_read_b128 v[24:27], v16 offset:1024
    ds_read_b64_tr_b16 v[52:53], v14 offset:4608
    ds_read_b64_tr_b16 v[54:55], v14 offset:4752
    s_waitcnt lgkmcnt(11)
    s_nop 0
    v_mfma_f32_16x16x32_bf16 v[64:67], v[32:35], v[20:23], 0
    ds_read_b64_tr_b16 v[56:57], v14 offset:4640
    ds_read_b64_tr_b16 v[58:59], v14 offset:4784
    s_waitcnt lgkmcnt(11)
    s_nop 0
    v_mfma_f32_16x16x32_bf16 v[68:71], v[36:39], v[20:23], 0
    ds_read_b64_tr_b16 v[60:61], v14 offset:4672
    ds_read_b64_tr_b16 v[62:63], v14 offset:4816
    s_waitcnt lgkmcnt(11)
    s_nop 0
    v_mfma_f32_16x16x32_bf16 v[72:75], v[40:43], v[20:23], 0
    ds_read_b64_tr_b16 v[32:33], v14 offset:4704
    ds_read_b64_tr_b16 v[34:35], v14 offset:4848
    s_waitcnt lgkmcnt(11)
    s_nop 0
    v_mfma_f32_16x16x32_bf16 v[76:79], v[44:47], v[20:23], 0
    ds_read_b64_tr_b16 v[36:37], v14 offset:4736
    ds_read_b64_tr_b16 v[38:39], v14 offset:4880
    s_waitcnt lgkmcnt(11)
    s_nop 0
    v_mfma_f32_16x16x32_bf16 v[80:83], v[48:51], v[20:23], 0
    ds_read_b128 v[28:31], v16 offset:2048
    ds_read_b64_tr_b16 v[40:41], v14 offset:9216
    ds_read_b64_tr_b16 v[42:43], v14 offset:9360
    s_waitcnt lgkmcnt(11)
    s_nop 0
    v_mfma_f32_16x16x32_bf16 v[64:67], v[52:55], v[24:27], v[64:67]
    ds_read_b64_tr_b16 v[44:45], v14 offset:9248
    ds_read_b64_tr_b16 v[46:47], v14 offset:9392
    s_waitcnt lgkmcnt(11)
    s_nop 0
    v_mfma_f32_16x16x32_bf16 v[68:71], v[56:59], v[24:27], v[68:71]
    ds_read_b64_tr_b16 v[48:49], v14 offset:9280
    ds_read_b64_tr_b16 v[50:51], v14 offset:9424
    s_waitcnt lgkmcnt(11)
    s_nop 0
    v_mfma_f32_16x16x32_bf16 v[72:75], v[60:63], v[24:27], v[72:75]
    ds_read_b64_tr_b16 v[52:53], v14 offset:9312
    ds_read_b64_tr_b16 v[54:55], v14 offset:9456
    s_waitcnt lgkmcnt(11)
    s_nop 0
    v_mfma_f32_16x16x32_bf16 v[76:79], v[32:35], v[24:27], v[76:79]
    ds_read_b64_tr_b16 v[56:57], v14 offset:9344
    ds_read_b64_tr_b16 v[58:59], v14 offset:9488
    s_waitcnt lgkmcnt(11)
    s_nop 0
    v_mfma_f32_16x16x32_bf16 v[80:83], v[36:39], v[24:27], v[80:83]
    ds_read_b128 v[20:23], v16 offset:3072
    ds_read_b64_tr_b16 v[60:61], v14 offset:13824
    ds_read_b64_tr_b16 v[62:63], v14 offset:13968
    s_waitcnt lgkmcnt(11)
    s_nop 0
    v_mfma_f32_16x16x32_bf16 v[64:67], v[40:43], v[28:31], v[64:67]
    ds_read_b64_tr_b16 v[32:33], v14 offset:13856
    ds_read_b64_tr_b16 v[34:35], v14 offset:14000
    s_waitcnt lgkmcnt(11)
    s_nop 0
    v_mfma_f32_16x16x32_bf16 v[68:71], v[44:47], v[28:31], v[68:71]
    ds_read_b64_tr_b16 v[36:37], v14 offset:13888
    ds_read_b64_tr_b16 v[38:39], v14 offset:14032
    s_waitcnt lgkmcnt(11)
    s_nop 0
    v_mfma_f32_16x16x32_bf16 v[72:75], v[48:51], v[28:31], v[72:75]
    ds_read_b64_tr_b16 v[40:41], v14 offset:13920
    ds_read_b64_tr_b16 v[42:43], v14 offset:14064
    s_waitcnt lgkmcnt(11)
    s_nop 0
    v_mfma_f32_16x16x32_bf16 v[76:79], v[52:55], v[28:31], v[76:79]
    ds_read_b64_tr_b16 v[44:45], v14 offset:13952
    ds_read_b64_tr_b16 v[46:47], v14 offset:14096
    s_waitcnt lgkmcnt(11)
    s_nop 0
    v_mfma_f32_16x16x32_bf16 v[80:83], v[56:59], v[28:31], v[80:83]
    ds_read_b128 v[24:27], v16 offset:4096
    ds_read_b64_tr_b16 v[48:49], v14 offset:18432
    ds_read_b64_tr_b16 v[50:51], v14 offset:18576
    s_waitcnt lgkmcnt(11)
    s_nop 0
    v_mfma_f32_16x16x32_bf16 v[64:67], v[60:63], v[20:23], v[64:67]
    ds_read_b64_tr_b16 v[52:53], v14 offset:18464
    ds_read_b64_tr_b16 v[54:55], v14 offset:18608
    s_waitcnt lgkmcnt(11)
    s_nop 0
    v_mfma_f32_16x16x32_bf16 v[68:71], v[32:35], v[20:23], v[68:71]
    ds_read_b64_tr_b16 v[56:57], v14 offset:18496
    ds_read_b64_tr_b16 v[58:59], v14 offset:18640
    s_waitcnt lgkmcnt(11)
    s_nop 0
    v_mfma_f32_16x16x32_bf16 v[72:75], v[36:39], v[20:23], v[72:75]
    ds_read_b64_tr_b16 v[60:61], v14 offset:18528
    ds_read_b64_tr_b16 v[62:63], v14 offset:18672
    s_waitcnt lgkmcnt(11)
    s_nop 0
    v_mfma_f32_16x16x32_bf16 v[76:79], v[40:43], v[20:23], v[76:79]
    ds_read_b64_tr_b16 v[32:33], v14 offset:18560
    ds_read_b64_tr_b16 v[34:35], v14 offset:18704
    s_waitcnt lgkmcnt(11)
    s_nop 0
    v_mfma_f32_16x16x32_bf16 v[80:83], v[44:47], v[20:23], v[80:83]
    ds_read_b128 v[28:31], v16 offset:5120
    ds_read_b64_tr_b16 v[36:37], v14 offset:23040
    ds_read_b64_tr_b16 v[38:39], v14 offset:23184
    s_waitcnt lgkmcnt(11)
    s_nop 0
    v_mfma_f32_16x16x32_bf16 v[64:67], v[48:51], v[24:27], v[64:67]
    ds_read_b64_tr_b16 v[40:41], v14 offset:23072
    ds_read_b64_tr_b16 v[42:43], v14 offset:23216
    s_waitcnt lgkmcnt(11)
    s_nop 0
    v_mfma_f32_16x16x32_bf16 v[68:71], v[52:55], v[24:27], v[68:71]
    ds_read_b64_tr_b16 v[44:45], v14 offset:23104
    ds_read_b64_tr_b16 v[46:47], v14 offset:23248
    s_waitcnt lgkmcnt(11)
    s_nop 0
    v_mfma_f32_16x16x32_bf16 v[72:75], v[56:59], v[24:27], v[72:75]
    ds_read_b64_tr_b16 v[48:49], v14 offset:23136
    ds_read_b64_tr_b16 v[50:51], v14 offset:23280
    s_waitcnt lgkmcnt(11)
    s_nop 0
    v_mfma_f32_16x16x32_bf16 v[76:79], v[60:63], v[24:27], v[76:79]
    ds_read_b64_tr_b16 v[52:53], v14 offset:23168
    ds_read_b64_tr_b16 v[54:55], v14 offset:23312
    s_waitcnt lgkmcnt(11)
    s_nop 0
    v_mfma_f32_16x16x32_bf16 v[80:83], v[32:35], v[24:27], v[80:83]
    s_mov_b32 s66, 160000
L_lw6:
    ds_read_b128 v[4:7], v2 offset:16
    s_waitcnt lgkmcnt(0)
    v_min_u32 v4, v4, v5
    v_min3_u32 v4, v4, v6, v7
    v_cmp_gt_u32 vcc, 1, v4
    s_cbranch_vccz L_lw6_ok
    s_sleep 1
    s_sub_u32 s66, s66, 1
    s_cmp_lg_u32 s66, 0
    s_cbranch_scc1 L_lw6
L_lw6_ok:
    ds_read_b128 v[20:23], v16 offset:6144
    ds_read_b64_tr_b16 v[56:57], v14 offset:27648
    ds_read_b64_tr_b16 v[58:59], v14 offset:27792
    v_mfma_f32_16x16x32_bf16 v[64:67], v[36:39], v[28:31], v[64:67]
    ds_read_b64_tr_b16 v[60:61], v14 offset:27680
    ds_read_b64_tr_b16 v[62:63], v14 offset:27824
    v_mfma_f32_16x16x32_bf16 v[68:71], v[40:43], v[28:31], v[68:71]
    ds_read_b64_tr_b16 v[32:33], v14 offset:27712
    ds_read_b64_tr_b16 v[34:35], v14 offset:27856
    v_mfma_f32_16x16x32_bf16 v[72:75], v[44:47], v[28:31], v[72:75]
    ds_read_b64_tr_b16 v[36:37], v14 offset:27744
    ds_read_b64_tr_b16 v[38:39], v14 offset:27888
    v_mfma_f32_16x16x32_bf16 v[76:79], v[48:51], v[28:31], v[76:79]
    ds_read_b64_tr_b16 v[40:41], v14 offset:27776
    ds_read_b64_tr_b16 v[42:43], v14 offset:27920
    v_mfma_f32_16x16x32_bf16 v[80:83], v[52:55], v[28:31], v[80:83]
    ds_read_b128 v[24:27], v16 offset:7168
    ds_read_b64_tr_b16 v[44:45], v14 offset:32256
    ds_read_b64_tr_b16 v[46:47], v14 offset:32400
    s_waitcnt lgkmcnt(11)
    s_nop 0
    v_mfma_f32_16x16x32_bf16 v[64:67], v[56:59], v[20:23], v[64:67]
    ds_read_b64_tr_b16 v[48:49], v14 offset:32288
    ds_read_b64_tr_b16 v[50:51], v14 offset:32432
    s_waitcnt lgkmcnt(11)
    s_nop 0
    v_mfma_f32_16x16x32_bf16 v[68:71], v[60:63], v[20:23], v[68:71]
    ds_read_b64_tr_b16 v[52:53], v14 offset:32320
    ds_read_b64_tr_b16 v[54:55], v14 offset:32464
    s_waitcnt lgkmcnt(11)
    s_nop 0
    v_mfma_f32_16x16x32_bf16 v[72:75], v[32:35], v[20:23], v[72:75]
    ds_read_b64_tr_b16 v[56:57], v14 offset:32352
    ds_read_b64_tr_b16 v[58:59], v14 offset:32496
    s_waitcnt lgkmcnt(11)
    s_nop 0
    v_mfma_f32_16x16x32_bf16 v[76:79], v[36:39], v[20:23], v[76:79]
    ds_read_b64_tr_b16 v[60:61], v14 offset:32384
    ds_read_b64_tr_b16 v[62:63], v14 offset:32528
    s_waitcnt lgkmcnt(11)
    s_nop 0
    v_mfma_f32_16x16x32_bf16 v[80:83], v[40:43], v[20:23], v[80:83]
    ds_read_b128 v[28:31], v16 offset:8192
    ds_read_b64_tr_b16 v[32:33], v14 offset:36864
    ds_read_b64_tr_b16 v[34:35], v14 offset:37008
    s_waitcnt lgkmcnt(11)
    s_nop 0
    v_mfma_f32_16x16x32_bf16 v[64:67], v[44:47], v[24:27], v[64:67]
    ds_read_b64_tr_b16 v[36:37], v14 offset:36896
    ds_read_b64_tr_b16 v[38:39], v14 offset:37040
    s_waitcnt lgkmcnt(11)
    s_nop 0
    v_mfma_f32_16x16x32_bf16 v[68:71], v[48:51], v[24:27], v[68:71]
    ds_read_b64_tr_b16 v[40:41], v14 offset:36928
    ds_read_b64_tr_b16 v[42:43], v14 offset:37072
    s_waitcnt lgkmcnt(11)
    s_nop 0
    v_mfma_f32_16x16x32_bf16 v[72:75], v[52:55], v[24:27], v[72:75]
    ds_read_b64_tr_b16 v[44:45], v14 offset:36960
    ds_read_b64_tr_b16 v[46:47], v14 offset:37104
    s_waitcnt lgkmcnt(11)
    s_nop 0
    v_mfma_f32_16x16x32_bf16 v[76:79], v[56:59], v[24:27], v[76:79]
    ds_read_b64_tr_b16 v[48:49], v14 offset:36992
    ds_read_b64_tr_b16 v[50:51], v14 offset:37136
    s_waitcnt lgkmcnt(11)
    s_nop 0
    v_mfma_f32_16x16x32_bf16 v[80:83], v[60:63], v[24:27], v[80:83]
    ds_read_b128 v[20:23], v16 offset:9216
    ds_read_b64_tr_b16 v[52:53], v15 offset:0
    ds_read_b64_tr_b16 v[54:55], v15 offset:144
    s_waitcnt lgkmcnt(11)
    s_nop 0
    v_mfma_f32_16x16x32_bf16 v[64:67], v[32:35], v[28:31], v[64:67]
    ds_read_b64_tr_b16 v[56:57], v15 offset:32
    ds_read_b64_tr_b16 v[58:59], v15 offset:176
    s_waitcnt lgkmcnt(11)
    s_nop 0
    v_mfma_f32_16x16x32_bf16 v[68:71], v[36:39], v[28:31], v[68:71]
    ds_read_b64_tr_b16 v[60:61], v15 offset:64
    ds_read_b64_tr_b16 v[62:63], v15 offset:208
    s_waitcnt lgkmcnt(11)
    s_nop 0
    v_mfma_f32_16x16x32_bf16 v[72:75], v[40:43], v[28:31], v[72:75]
    ds_read_b64_tr_b16 v[32:33], v15 offset:96
    ds_read_b64_tr_b16 v[34:35], v15 offset:240
    s_waitcnt lgkmcnt(11)
    s_nop 0
    v_mfma_f32_16x16x32_bf16 v[76:79], v[44:47], v[28:31], v[76:79]
    ds_read_b64_tr_b16 v[36:37], v15 offset:128
    ds_read_b64_tr_b16 v[38:39], v15 offset:272
    s_waitcnt lgkmcnt(11)
    s_nop 0
    v_mfma_f32_16x16x32_bf16 v[80:83], v[48:51], v[28:31], v[80:83]
    ds_read_b128 v[24:27], v16 offset:10240
    ds_read_b64_tr_b16 v[40:41], v15 offset:4608
    ds_read_b64_tr_b16 v[42:43], v15 offset:4752
    s_waitcnt lgkmcnt(11)
    s_nop 0
    v_mfma_f32_16x16x32_bf16 v[64:67], v[52:55], v[20:23], v[64:67]
    ds_read_b64_tr_b16 v[44:45], v15 offset:4640
    ds_read_b64_tr_b16 v[46:47], v15 offset:4784
    s_waitcnt lgkmcnt(11)
    s_nop 0
    v_mfma_f32_16x16x32_bf16 v[68:71], v[56:59], v[20:23], v[68:71]
    ds_read_b64_tr_b16 v[48:49], v15 offset:4672
    ds_read_b64_tr_b16 v[50:51], v15 offset:4816
    s_waitcnt lgkmcnt(11)
    s_nop 0
    v_mfma_f32_16x16x32_bf16 v[72:75], v[60:63], v[20:23], v[72:75]
    ds_read_b64_tr_b16 v[52:53], v15 offset:4704
    ds_read_b64_tr_b16 v[54:55], v15 offset:4848
    s_waitcnt lgkmcnt(11)
    s_nop 0
    v_mfma_f32_16x16x32_bf16 v[76:79], v[32:35], v[20:23], v[76:79]
    ds_read_b64_tr_b16 v[56:57], v15 offset:4736
    ds_read_b64_tr_b16 v[58:59], v15 offset:4880
    s_waitcnt lgkmcnt(11)
    s_nop 0
    v_mfma_f32_16x16x32_bf16 v[80:83], v[36:39], v[20:23], v[80:83]
    ds_read_b128 v[28:31], v16 offset:11264
    ds_read_b64_tr_b16 v[60:61], v15 offset:9216
    ds_read_b64_tr_b16 v[62:63], v15 offset:9360
    s_waitcnt lgkmcnt(11)
    s_nop 0
    v_mfma_f32_16x16x32_bf16 v[64:67], v[40:43], v[24:27], v[64:67]
    ds_read_b64_tr_b16 v[32:33], v15 offset:9248
    ds_read_b64_tr_b16 v[34:35], v15 offset:9392
    s_waitcnt lgkmcnt(11)
    s_nop 0
    v_mfma_f32_16x16x32_bf16 v[68:71], v[44:47], v[24:27], v[68:71]
    ds_read_b64_tr_b16 v[36:37], v15 offset:9280
    ds_read_b64_tr_b16 v[38:39], v15 offset:9424
    s_waitcnt lgkmcnt(11)
    s_nop 0
    v_mfma_f32_16x16x32_bf16 v[72:75], v[48:51], v[24:27], v[72:75]
    ds_read_b64_tr_b16 v[40:41], v15 offset:9312
    ds_read_b64_tr_b16 v[42:43], v15 offset:9456
    s_waitcnt lgkmcnt(11)
    s_nop 0
    v_mfma_f32_16x16x32_bf16 v[76:79], v[52:55], v[24:27], v[76:79]
    ds_read_b64_tr_b16 v[44:45], v15 offset:9344
    ds_read_b64_tr_b16 v[46:47], v15 offset:9488
    s_waitcnt lgkmcnt(11)
    s_nop 0
    v_mfma_f32_16x16x32_bf16 v[80:83], v[56:59], v[24:27], v[80:83]
    s_mov_b32 s66, 160000
L_lw7:
    ds_read_b128 v[4:7], v2 offset:32
    s_waitcnt lgkmcnt(0)
    v_min_u32 v4, v4, v5
    v_min3_u32 v4, v4, v6, v7
    v_cmp_gt_u32 vcc, 1, v4
    s_cbranch_vccz L_lw7_ok
    s_sleep 1
    s_sub_u32 s66, s66, 1
    s_cmp_lg_u32 s66, 0
    s_cbranch_scc1 L_lw7
L_lw7_ok:
    ds_read_b128 v[20:23], v16 offset:12288
    ds_read_b64_tr_b16 v[48:49], v15 offset:13824
    ds_read_b64_tr_b16 v[50:51], v15 offset:13968
    v_mfma_f32_16x16x32_bf16 v[64:67], v[60:63], v[28:31], v[64:67]
    ds_read_b64_tr_b16 v[52:53], v15 offset:13856
    ds_read_b64_tr_b16 v[54:55], v15 offset:14000
    v_mfma_f32_16x16x32_bf16 v[68:71], v[32:35], v[28:31], v[68:71]
    ds_read_b64_tr_b16 v[56:57], v15 offset:13888
    ds_read_b64_tr_b16 v[58:59], v15 offset:14032
    v_mfma_f32_16x16x32_bf16 v[72:75], v[36:39], v[28:31], v[72:75]
    ds_read_b64_tr_b16 v[60:61], v15 offset:13920
    ds_read_b64_tr_b16 v[62:63], v15 offset:14064
    v_mfma_f32_16x16x32_bf16 v[76:79], v[40:43], v[28:31], v[76:79]
    ds_read_b64_tr_b16 v[32:33], v15 offset:13952
    ds_read_b64_tr_b16 v[34:35], v15 offset:14096
    v_mfma_f32_16x16x32_bf16 v[80:83], v[44:47], v[28:31], v[80:83]
    ds_read_b128 v[24:27], v16 offset:13312
    ds_read_b64_tr_b16 v[36:37], v15 offset:18432
    ds_read_b64_tr_b16 v[38:39], v15 offset:18576
    s_waitcnt lgkmcnt(11)
    s_nop 0
    v_mfma_f32_16x16x32_bf16 v[64:67], v[48:51], v[20:23], v[64:67]
    ds_read_b64_tr_b16 v[40:41], v15 offset:18464
    ds_read_b64_tr_b16 v[42:43], v15 offset:18608
    s_waitcnt lgkmcnt(11)
    s_nop 0
    v_mfma_f32_16x16x32_bf16 v[68:71], v[52:55], v[20:23], v[68:71]
    ds_read_b64_tr_b16 v[44:45], v15 offset:18496
    ds_read_b64_tr_b16 v[46:47], v15 offset:18640
    s_waitcnt lgkmcnt(11)
    s_nop 0
    v_mfma_f32_16x16x32_bf16 v[72:75], v[56:59], v[20:23], v[72:75]
    ds_read_b64_tr_b16 v[48:49], v15 offset:18528
    ds_read_b64_tr_b16 v[50:51], v15 offset:18672
    s_waitcnt lgkmcnt(11)
    s_nop 0
    v_mfma_f32_16x16x32_bf16 v[76:79], v[60:63], v[20:23], v[76:79]
    ds_read_b64_tr_b16 v[52:53], v15 offset:18560
    ds_read_b64_tr_b16 v[54:55], v15 offset:18704
    s_waitcnt lgkmcnt(11)
    s_nop 0
    v_mfma_f32_16x16x32_bf16 v[80:83], v[32:35], v[20:23], v[80:83]
    ds_read_b128 v[28:31], v16 offset:14336
    ds_read_b64_tr_b16 v[56:57], v15 offset:23040
    ds_read_b64_tr_b16 v[58:59], v15 offset:23184
    s_waitcnt lgkmcnt(11)
    s_nop 0
    v_mfma_f32_16x16x32_bf16 v[64:67], v[36:39], v[24:27], v[64:67]
    ds_read_b64_tr_b16 v[60:61], v15 offset:23072
    ds_read_b64_tr_b16 v[62:63], v15 offset:23216
    s_waitcnt lgkmcnt(11)
    s_nop 0
    v_mfma_f32_16x16x32_bf16 v[68:71], v[40:43], v[24:27], v[68:71]
    ds_read_b64_tr_b16 v[32:33], v15 offset:23104
    ds_read_b64_tr_b16 v[34:35], v15 offset:23248
    s_waitcnt lgkmcnt(11)
    s_nop 0
    v_mfma_f32_16x16x32_bf16 v[72:75], v[44:47], v[24:27], v[72:75]
    ds_read_b64_tr_b16 v[36:37], v15 offset:23136
    ds_read_b64_tr_b16 v[38:39], v15 offset:23280
    s_waitcnt lgkmcnt(11)
    s_nop 0
    v_mfma_f32_16x16x32_bf16 v[76:79], v[48:51], v[24:27], v[76:79]
    ds_read_b64_tr_b16 v[40:41], v15 offset:23168
    ds_read_b64_tr_b16 v[42:43], v15 offset:23312
    s_waitcnt lgkmcnt(11)
    s_nop 0
    v_mfma_f32_16x16x32_bf16 v[80:83], v[52:55], v[24:27], v[80:83]
    ds_read_b128 v[20:23], v16 offset:15360
    ds_read_b64_tr_b16 v[44:45], v15 offset:27648
    ds_read_b64_tr_b16 v[46:47], v15 offset:27792
    s_waitcnt lgkmcnt(11)
    s_nop 0
    v_mfma_f32_16x16x32_bf16 v[64:67], v[56:59], v[28:31], v[64:67]
    ds_read_b64_tr_b16 v[48:49], v15 offset:27680
    ds_read_b64_tr_b16 v[50:51], v15 offset:27824
    s_waitcnt lgkmcnt(11)
    s_nop 0
    v_mfma_f32_16x16x32_bf16 v[68:71], v[60:63], v[28:31], v[68:71]
    ds_read_b64_tr_b16 v[52:53], v15 offset:27712
    ds_read_b64_tr_b16 v[54:55], v15 offset:27856
    s_waitcnt lgkmcnt(11)
    s_nop 0
    v_mfma_f32_16x16x32_bf16 v[72:75], v[32:35], v[28:31], v[72:75]
    ds_read_b64_tr_b16 v[56:57], v15 offset:27744
    ds_read_b64_tr_b16 v[58:59], v15 offset:27888
    s_waitcnt lgkmcnt(11)
    s_nop 0
    v_mfma_f32_16x16x32_bf16 v[76:79], v[36:39], v[28:31], v[76:79]
    ds_read_b64_tr_b16 v[60:61], v15 offset:27776
    ds_read_b64_tr_b16 v[62:63], v15 offset:27920
    s_waitcnt lgkmcnt(11)
    s_nop 0
    v_mfma_f32_16x16x32_bf16 v[80:83], v[40:43], v[28:31], v[80:83]
    ds_read_b128 v[24:27], v16 offset:16384
    ds_read_b64_tr_b16 v[32:33], v15 offset:32256
    ds_read_b64_tr_b16 v[34:35], v15 offset:32400
    s_waitcnt lgkmcnt(11)
    s_nop 0
    v_mfma_f32_16x16x32_bf16 v[64:67], v[44:47], v[20:23], v[64:67]
    ds_read_b64_tr_b16 v[36:37], v15 offset:32288
    ds_read_b64_tr_b16 v[38:39], v15 offset:32432
    s_waitcnt lgkmcnt(11)
    s_nop 0
    v_mfma_f32_16x16x32_bf16 v[68:71], v[48:51], v[20:23], v[68:71]
    ds_read_b64_tr_b16 v[40:41], v15 offset:32320
    ds_read_b64_tr_b16 v[42:43], v15 offset:32464
    s_waitcnt lgkmcnt(11)
    s_nop 0
    v_mfma_f32_16x16x32_bf16 v[72:75], v[52:55], v[20:23], v[72:75]
    ds_read_b64_tr_b16 v[44:45], v15 offset:32352
    ds_read_b64_tr_b16 v[46:47], v15 offset:32496
    s_waitcnt lgkmcnt(11)
    s_nop 0
    v_mfma_f32_16x16x32_bf16 v[76:79], v[56:59], v[20:23], v[76:79]
    ds_read_b64_tr_b16 v[48:49], v15 offset:32384
    ds_read_b64_tr_b16 v[50:51], v15 offset:32528
    s_waitcnt lgkmcnt(11)
    s_nop 0
    v_mfma_f32_16x16x32_bf16 v[80:83], v[60:63], v[20:23], v[80:83]
    ds_read_b128 v[28:31], v16 offset:17408
    ds_read_b64_tr_b16 v[52:53], v15 offset:36864
    ds_read_b64_tr_b16 v[54:55], v15 offset:37008
    s_waitcnt lgkmcnt(11)
    s_nop 0
    v_mfma_f32_16x16x32_bf16 v[64:67], v[32:35], v[24:27], v[64:67]
    ds_read_b64_tr_b16 v[56:57], v15 offset:36896
    ds_read_b64_tr_b16 v[58:59], v15 offset:37040
    s_waitcnt lgkmcnt(11)
    s_nop 0
    v_mfma_f32_16x16x32_bf16 v[68:71], v[36:39], v[24:27], v[68:71]
    ds_read_b64_tr_b16 v[60:61], v15 offset:36928
    ds_read_b64_tr_b16 v[62:63], v15 offset:37072
    s_waitcnt lgkmcnt(11)
    s_nop 0
    v_mfma_f32_16x16x32_bf16 v[72:75], v[40:43], v[24:27], v[72:75]
    ds_read_b64_tr_b16 v[32:33], v15 offset:36960
    ds_read_b64_tr_b16 v[34:35], v15 offset:37104
    s_waitcnt lgkmcnt(11)
    s_nop 0
    v_mfma_f32_16x16x32_bf16 v[76:79], v[44:47], v[24:27], v[76:79]
    ds_read_b64_tr_b16 v[36:37], v15 offset:36992
    ds_read_b64_tr_b16 v[38:39], v15 offset:37136
    s_waitcnt lgkmcnt(11)
    s_nop 0
    v_mfma_f32_16x16x32_bf16 v[80:83], v[48:51], v[24:27], v[80:83]
    s_waitcnt lgkmcnt(8)
    s_nop 0
    v_mfma_f32_16x16x32_bf16 v[64:67], v[52:55], v[28:31], v[64:67]
    s_waitcnt lgkmcnt(6)
    s_nop 0
    v_mfma_f32_16x16x32_bf16 v[68:71], v[56:59], v[28:31], v[68:71]
    s_waitcnt lgkmcnt(4)
    s_nop 0
    v_mfma_f32_16x16x32_bf16 v[72:75], v[60:63], v[28:31], v[72:75]
    s_waitcnt lgkmcnt(2)
    s_nop 0
    v_mfma_f32_16x16x32_bf16 v[76:79], v[32:35], v[28:31], v[76:79]
    s_waitcnt lgkmcnt(0)
    s_nop 0
    v_mfma_f32_16x16x32_bf16 v[80:83], v[36:39], v[28:31], v[80:83]
    s_mov_b32 s66, 160000
L_lw8:
    ds_read_b32 v4, v19 offset:64
    s_waitcnt lgkmcnt(0)
    v_cmp_gt_u32 vcc, 1, v4
    s_cbranch_vccz L_lw8_ok
    s_sleep 1
    s_sub_u32 s66, s66, 1
    s_cmp_lg_u32 s66, 0
    s_cbranch_scc1 L_lw8
L_lw8_ok:
    s_nop 0
    s_mov_b32 s60, 1051597459
    v_mul_f32 v64, s60, v64
    v_mul_f32 v65, s60, v65
    v_mul_f32 v66, s60, v66
    v_mul_f32 v67, s60, v67
    v_cvt_pk_bf16_f32 v64, v64, v65
    v_cvt_pk_bf16_f32 v65, v66, v67
    ds_write_b32 v84, v64
    ds_write_b32 v85, v65
    v_mul_f32 v68, s60, v68
    v_mul_f32 v69, s60, v69
    v_mul_f32 v70, s60, v70
    v_mul_f32 v71, s60, v71
    v_cvt_pk_bf16_f32 v68, v68, v69
    v_cvt_pk_bf16_f32 v69, v70, v71
    ds_write_b32 v86, v68
    ds_write_b32 v87, v69
    v_mul_f32 v72, s60, v72
    v_mul_f32 v73, s60, v73
    v_mul_f32 v74, s60, v74
    v_mul_f32 v75, s60, v75
    v_cvt_pk_bf16_f32 v72, v72, v73
    v_cvt_pk_bf16_f32 v73, v74, v75
    ds_write_b32 v88, v72
    ds_write_b32 v89, v73
    v_mul_f32 v76, s60, v76
    v_mul_f32 v77, s60, v77
    v_mul_f32 v78, s60, v78
    v_mul_f32 v79, s60, v79
    v_cvt_pk_bf16_f32 v76, v76, v77
    v_cvt_pk_bf16_f32 v77, v78, v79
    ds_write_b32 v90, v76
    ds_write_b32 v91, v77
    v_mul_f32 v80, s60, v80
    v_mul_f32 v81, s60, v81
    v_mul_f32 v82, s60, v82
    v_mul_f32 v83, s60, v83
    v_cvt_pk_bf16_f32 v80, v80, v81
    v_cvt_pk_bf16_f32 v81, v82, v83
    ds_write_b32 v92, v80
    ds_write_b32 v93, v81
L_a_b3a:
    s_waitcnt lgkmcnt(0)
    s_barrier
    s_lshl_b32 s60, s3, 10
    s_add_u32 s61, s60, 0
    s_mov_b32 m0, s61
    s_nop 0
    buffer_load_dwordx4 v1, s[40:43], s61 offen lds
    s_add_u32 s61, s60, 75776
    s_mov_b32 m0, s61
    s_nop 0
    buffer_load_dwordx4 v1, s[40:43], s61 offen lds
    s_cmp_lt_u32 s3, 6
    s_cbranch_scc0 L_a_c0d
    s_add_u32 s61, s60, 8192
    s_mov_b32 m0, s61
    s_nop 0
    buffer_load_dwordx4 v1, s[40:43], s61 offen lds
    s_add_u32 s61, s60, 83968
    s_mov_b32 m0, s61
    s_nop 0
    buffer_load_dwordx4 v1, s[40:43], s61 offen lds
L_a_c0d:
    s_mul_i32 s60, s6, 576
    s_add_u32 s60, s60, 15360
    v_bfe_u32 v42, v0, 4, 1
    v_mul_u32_u24 v42, 18432, v42
    v_add_u32 v42, s60, v42
    v_and_b32 v44, 15, v0
    v_lshl_add_u32 v43, v44, 2, v42
    v_lshl_add_u32 v42, v44, 4, v42
    v_lshrrev_b32_e64 v45, 5, v0
    v_lshl_add_u32 v42, v45, 8, v42
    ds_read_b128 v[4:7], v42
    ds_read_b128 v[12:15], v42 offset:36864
    v_mul_u32_u24 v46, 36864, v45
    v_add_u32_e64 v43, v43, v46
    ds_read_b32 v8, v43 offset:512
    v_and_b32 v44, 31, v0
    v_lshlrev_b32 v38, 2, v44
    v_mov_b32 v36, 0xdddd
    v_mov_b32 v25, 0x3f80
    v_mov_b32 v27, 0x3f80
    v_mov_b32_e64 v9, 0
    s_mul_i32 s61, s7, 75776
    v_add_u32 v37, s61, v1
    v_add_u32 v38, s61, v38
    v_mul_u32_u24 v43, 288, v45
    v_lshl_add_u32 v43, v44, 4, v43
    v_and_b32 v45, 27, v44
    v_cmp_eq_u32 vcc, 24, v45
    v_mov_b32 v45, 576
    v_mov_b32 v46, 592
    v_cndmask_b32 v45, v46, v45, vcc
    v_cmp_gt_u32 vcc, 18, v44
    s_lshl_b32 s64, s5, 2
    s_nop 0
    v_cndmask_b32 v39, v45, v43, vcc
    v_add_u32 v39, s61, v39
    s_add_u32 s64, s64, s6
    v_cmp_gt_u32 vcc, 32, v0
    s_mov_b32 s65, 0
    s_nop 0
    s_mov_b32 s72, 0x130
    v_mov_b32_e64 v144, v2
    v_add_u32 v2, 112, v2
    s_waitcnt lgkmcnt(0)
    v_mov_b32 v112, 0
    v_mov_b32 v113, 0
    v_mov_b32 v114, 0
    v_mov_b32 v115, 0
    v_mov_b32 v116, 0
    v_mov_b32 v117, 0
    v_mov_b32 v118, 0
    v_mov_b32 v119, 0
    v_mov_b32 v120, 0
    v_mov_b32 v121, 0
    v_mov_b32 v122, 0
    v_mov_b32 v123, 0
    v_mov_b32 v124, 0
    v_mov_b32 v125, 0
    v_mov_b32 v126, 0
    v_mov_b32 v127, 0
    v_mov_b32 v128, 0
    v_mov_b32 v129, 0
    v_mov_b32 v130, 0
    v_mov_b32 v131, 0
    v_mov_b32 v132, 0
    v_mov_b32 v133, 0
    v_mov_b32 v134, 0
    v_mov_b32 v135, 0
    v_mov_b32 v136, 0
    v_mov_b32 v137, 0
    v_mov_b32 v138, 0
    v_mov_b32 v139, 0
    v_mov_b32 v140, 0
    v_mov_b32 v141, 0
    v_mov_b32 v142, 0
    v_mov_b32 v143, 0
    v_mov_b32 v104, 0
    v_mov_b32 v105, 0
    v_mov_b32 v106, 0
    v_mov_b32 v107, 0
    v_mov_b32 v108, 0
    v_mov_b32 v109, 0
    v_mov_b32 v110, 0
    v_mov_b32 v111, 0
    v_mov_b32 v32, 0
    v_mov_b32 v33, 0
    v_mov_b32 v34, 0
    v_mov_b32_e64 v35, 0
    s_cmp_lt_u32 s3, 6
    s_cbranch_scc1 L_a_w4
    s_waitcnt vmcnt(0)
L_a_w4:
    s_waitcnt vmcnt(2)
    s_barrier
    s_cmp_eq_u32 s7, 1
    s_cbranch_scc0 L_a_np
    s_setprio 1
L_a_np:
    ds_read_b128 v[16:19], v37 offset:0
    ds_read_b32 v24, v38 offset:1024
    s_waitcnt lgkmcnt(0)
    s_nop 0
    v_mfma_f32_32x32x4_2b_bf16 v[48:79], v[24:25], v[8:9], 0
    s_nop 15
    s_nop 1
    v_mfma_f32_32x32x16_bf16 v[48:63], v[16:19], v[4:7], v[48:63]
    v_mfma_f32_32x32x16_bf16 v[64:79], v[16:19], v[12:15], v[64:79]
    s_nop 10
    s_nop 0
    v_max3_f32 v40, v48, v49, v50
    v_max3_f32 v40, v40, v51, v52
    v_max3_f32 v40, v40, v53, v54
    v_max3_f32 v40, v40, v55, v56
    v_max3_f32 v40, v40, v57, v58
    v_max3_f32 v40, v40, v59, v60
    v_max3_f32 v40, v40, v61, v62
    v_max_f32_e64 v40, v40, v63
    v_max3_f32 v41, v64, v65, v66
    v_max3_f32 v41, v41, v67, v68
    v_max3_f32 v41, v41, v69, v70
    v_max3_f32 v41, v41, v71, v72
    v_max3_f32 v41, v41, v73, v74
    v_max3_f32 v41, v41, v75, v76
    v_max3_f32 v41, v41, v77, v78
    v_max_f32 v41, v41, v79
    v_mov_b32 v42, v40
    v_mov_b32 v43, v41
    s_nop 1
    v_permlane32_swap_b32 v40, v42
    v_permlane32_swap_b32 v41, v43
    v_cmp_gt_u32 vcc, 32, v0
    v_max_f32 v40, v40, v42
    v_cvt_pk_bf16_f32 v42, -v40, 0
    v_lshlrev_b32 v40, 16, v42
    v_max_f32 v41, v41, v43
    v_cvt_pk_bf16_f32 v43, -v41, 0
    v_lshlrev_b32_e64 v41, 16, v43
    v_cndmask_b32 v9, v43, v42, vcc
    s_waitcnt vmcnt(0)
    s_barrier
    s_branch L_a_rs2
L_a_restart:
    ds_read_b128 v[16:19], v37 offset:0
    ds_read_b32 v24, v38 offset:1024
L_a_rs2:
    ds_read_b128 v[20:23], v37 offset:2368
    ds_read_b32 v26, v38 offset:3392
    ds_read_b128 v[28:31], v39 offset:1152
    s_waitcnt lgkmcnt(3)
    s_nop 0
    v_mfma_f32_32x32x4_2b_bf16 v[48:79], v[24:25], v[8:9], 0
    s_nop 15
    s_nop 1
    v_mfma_f32_32x32x16_bf16 v[48:63], v[16:19], v[4:7], v[48:63]
    v_mfma_f32_32x32x16_bf16 v[64:79], v[16:19], v[12:15], v[64:79]
    s_waitcnt lgkmcnt(1)
    s_mov_b32 s66, 8
    s_nop 10
    .p2align 6
L_a_loop:
    v_exp_f32 v48, v48
    v_exp_f32 v49, v49
    v_exp_f32_e64 v50, v50
    v_smfmac_f32_32x32x32_bf16 v[128:143], v[32:35], v[104:111], v36
    ds_read_b128 v[32:35], v39 offset:1760
    ds_read_b128 v[16:19], v37 offset:4736
    ds_read_b32 v24, v38 offset:5760
    v_exp_f32 v51, v51
    v_exp_f32 v52, v52
    v_exp_f32 v53, v53
    v_exp_f32 v54, v54
    v_mfma_f32_32x32x4_2b_bf16 v[80:111], v[26:27], v[8:9], 0
    v_exp_f32 v55, v55
    v_exp_f32 v56, v56
    v_exp_f32 v57, v57
    v_exp_f32 v58, v58
    v_exp_f32 v59, v59
    v_exp_f32 v60, v60
    v_exp_f32_e64 v61, v61
    v_exp_f32 v62, v62
    s_waitcnt lgkmcnt(0)
    v_smfmac_f32_32x32x32_bf16 v[112:127], v[28:31], v[48:55], v36
    v_exp_f32 v63, v63
    v_exp_f32 v64, v64
    v_exp_f32 v65, v65
    v_exp_f32 v66, v66
    v_smfmac_f32_32x32x32_bf16 v[112:127], v[32:35], v[56:63], v36
    v_exp_f32 v67, v67
    v_exp_f32 v68, v68
    v_exp_f32 v69, v69
    v_exp_f32 v70, v70
    v_mfma_f32_32x32x16_bf16 v[80:95], v[20:23], v[4:7], v[80:95]
    v_exp_f32 v71, v71
    v_exp_f32 v72, v72
    v_exp_f32 v73, v73
    v_exp_f32 v74, v74
    v_smfmac_f32_32x32x32_bf16 v[128:143], v[28:31], v[64:71], v36
    ds_read_b128 v[28:31], v39 offset:3520
    v_exp_f32 v75, v75
    v_exp_f32 v76, v76
    v_exp_f32 v77, v77
    v_exp_f32 v78, v78
    v_mfma_f32_32x32x16_bf16 v[96:111], v[20:23], v[12:15], v[96:111]
    v_exp_f32 v79, v79
    v_exp_f32 v80, v80
    v_exp_f32 v81, v81
    v_exp_f32 v82, v82
    v_smfmac_f32_32x32x32_bf16 v[128:143], v[32:35], v[72:79], v36
    ds_read_b128 v[32:35], v39 offset:4128
    ds_read_b128 v[20:23], v37 offset:7104
    ds_read_b32 v26, v38 offset:8128
    v_exp_f32 v83, v83
    v_exp_f32 v84, v84
    v_exp_f32 v85, v85
    v_exp_f32 v86, v86
    v_mfma_f32_32x32x4_2b_bf16 v[48:79], v[24:25], v[8:9], 0
    v_exp_f32 v87, v87
    v_exp_f32 v88, v88
    v_exp_f32 v89, v89
    v_exp_f32 v90, v90
    v_exp_f32 v91, v91
    v_exp_f32 v92, v92
    v_exp_f32_e64 v93, v93
    v_exp_f32 v94, v94
    s_waitcnt lgkmcnt(0)
    v_smfmac_f32_32x32x32_bf16 v[112:127], v[28:31], v[80:87], v36
    v_exp_f32 v95, v95
    v_exp_f32 v96, v96
    v_exp_f32 v97, v97
    v_exp_f32 v98, v98
    v_smfmac_f32_32x32x32_bf16 v[112:127], v[32:35], v[88:95], v36
    v_exp_f32 v99, v99
    v_exp_f32 v100, v100
    v_exp_f32 v101, v101
    v_exp_f32 v102, v102
    v_mfma_f32_32x32x16_bf16 v[48:63], v[16:19], v[4:7], v[48:63]
    v_exp_f32 v103, v103
    v_exp_f32 v104, v104
    v_exp_f32 v105, v105
    v_exp_f32 v106, v106
    v_smfmac_f32_32x32x32_bf16 v[128:143], v[28:31], v[96:103], v36
    ds_read_b128 v[28:31], v39 offset:5888
    v_exp_f32 v107, v107
    v_exp_f32 v108, v108
    v_exp_f32 v109, v109
    v_exp_f32 v110, v110
    v_mfma_f32_32x32x16_bf16 v[64:79], v[16:19], v[12:15], v[64:79]
    v_exp_f32 v111, v111
    v_exp_f32 v48, v48
    v_exp_f32 v49, v49
    v_exp_f32 v50, v50
    v_smfmac_f32_32x32x32_bf16 v[128:143], v[32:35], v[104:111], v36
    ds_read_b128 v[32:35], v39 offset:6496
    ds_read_b128 v[16:19], v37 offset:9472
    ds_read_b32 v24, v38 offset:10496
    v_exp_f32 v51, v51
    v_exp_f32 v52, v52
    v_exp_f32 v53, v53
    v_exp_f32 v54, v54
    v_mfma_f32_32x32x4_2b_bf16 v[80:111], v[26:27], v[8:9], 0
    v_exp_f32 v55, v55
    v_exp_f32 v56, v56
    v_exp_f32 v57, v57
    v_exp_f32 v58, v58
    v_exp_f32 v59, v59
    v_exp_f32 v60, v60
    v_exp_f32_e64 v61, v61
    v_exp_f32 v62, v62
    s_waitcnt lgkmcnt(0)
    v_smfmac_f32_32x32x32_bf16 v[112:127], v[28:31], v[48:55], v36
    v_exp_f32 v63, v63
    v_exp_f32 v64, v64
    v_exp_f32 v65, v65
    v_exp_f32 v66, v66
    v_smfmac_f32_32x32x32_bf16 v[112:127], v[32:35], v[56:63], v36
    v_exp_f32 v67, v67
    v_exp_f32 v68, v68
    v_exp_f32 v69, v69
    v_exp_f32 v70, v70
    v_mfma_f32_32x32x16_bf16 v[80:95], v[20:23], v[4:7], v[80:95]
    v_exp_f32 v71, v71
    v_exp_f32 v72, v72
    v_exp_f32 v73, v73
    v_exp_f32 v74, v74
    v_smfmac_f32_32x32x32_bf16 v[128:143], v[28:31], v[64:71], v36
    ds_read_b128 v[28:31], v39 offset:8256
    v_exp_f32 v75, v75
    v_exp_f32 v76, v76
    v_exp_f32 v77, v77
    v_exp_f32 v78, v78
    v_mfma_f32_32x32x16_bf16 v[96:111], v[20:23], v[12:15], v[96:111]
    v_exp_f32 v79, v79
    v_exp_f32 v80, v80
    v_exp_f32 v81, v81
    v_exp_f32 v82, v82
    v_smfmac_f32_32x32x32_bf16 v[128:143], v[32:35], v[72:79], v36
    ds_read_b128 v[32:35], v39 offset:8864
    ds_read_b128 v[20:23], v37 offset:11840
    ds_read_b32 v26, v38 offset:12864
    v_exp_f32 v83, v83
    v_exp_f32 v84, v84
    v_exp_f32 v85, v85
    v_exp_f32 v86, v86
    v_mfma_f32_32x32x4_2b_bf16 v[48:79], v[24:25], v[8:9], 0
    v_exp_f32 v87, v87
    v_exp_f32 v88, v88
    v_exp_f32 v89, v89
    v_exp_f32 v90, v90
    v_exp_f32 v91, v91
    v_exp_f32 v92, v92
    v_exp_f32_e64 v93, v93
    v_exp_f32 v94, v94
    s_waitcnt lgkmcnt(0)
    v_smfmac_f32_32x32x32_bf16 v[112:127], v[28:31], v[80:87], v36
    v_exp_f32 v95, v95
    v_exp_f32 v96, v96
    v_exp_f32 v97, v97
    v_exp_f32 v98, v98
    v_smfmac_f32_32x32x32_bf16 v[112:127], v[32:35], v[88:95], v36
    v_exp_f32 v99, v99
    v_exp_f32 v100, v100
    v_exp_f32 v101, v101
    v_exp_f32 v102, v102
    v_mfma_f32_32x32x16_bf16 v[48:63], v[16:19], v[4:7], v[48:63]
    v_exp_f32 v103, v103
    v_exp_f32 v104, v104
    v_exp_f32 v105, v105
    v_exp_f32 v106, v106
    v_smfmac_f32_32x32x32_bf16 v[128:143], v[28:31], v[96:103], v36
    ds_read_b128 v[28:31], v39 offset:10624
    v_exp_f32 v107, v107
    v_exp_f32 v108, v108
    v_exp_f32 v109, v109
    v_exp_f32 v110, v110
    v_mfma_f32_32x32x16_bf16 v[64:79], v[16:19], v[12:15], v[64:79]
    v_exp_f32_e64 v111, v111
    v_add_u32 v37, 9472, v37
    v_add_u32 v38, 9472, v38
    v_add_u32 v39, 9472, v39
    s_add_u32 s67, s66, s65
    s_bitcmp1_b32 s72, s67
    s_cbranch_scc0 L_a_nobar
    v_add_u32 v2, 16, v2
    s_mov_b32 s67, 160000
L_lw9:
    ds_read_b128 v[44:47], v2 offset:0
    s_waitcnt lgkmcnt(0)
    v_min_u32 v44, v44, v45
    v_min3_u32 v44, v44, v46, v47
    v_cmp_gt_u32 vcc, 1, v44
    s_cbranch_vccz L_lw9_ok
    s_sleep 1
    s_sub_u32 s67, s67, 1
    s_cmp_lg_u32 s67, 0
    s_cbranch_scc1 L_lw9
L_lw9_ok:
L_a_nobar:
    s_sub_u32 s66, s66, 1
    s_cmp_lg_u32 s66, 0
    s_cbranch_scc1 L_a_loop
    s_nop 0
    v_smfmac_f32_32x32x32_bf16 v[128:143], v[32:35], v[104:111], v36
    v_subrev_u32 v37, 75776, v37
    v_subrev_u32 v38, 75776, v38
    v_subrev_u32 v39, 75776, v39
    s_waitcnt lgkmcnt(0)
    s_nop 9
    s_cmp_eq_u32 s65, 0
    s_cbranch_scc0 L_a_ok
    v_add_f32 v42, |v112|, |v128|
    v_add_f32 v42, v42, |v113|
    v_add_f32 v42, v42, |v129|
    v_add_f32 v42, v42, |v114|
    v_add_f32 v42, v42, |v130|
    v_add_f32 v42, v42, |v115|
    v_add_f32 v42, v42, |v131|
    v_add_f32 v42, v42, |v116|
    v_add_f32 v42, v42, |v132|
    v_add_f32 v42, v42, |v117|
    v_add_f32 v42, v42, |v133|
    v_add_f32 v42, v42, |v118|
    v_add_f32 v42, v42, |v134|
    v_add_f32 v42, v42, |v119|
    v_add_f32 v42, v42, |v135|
    v_add_f32 v42, v42, |v120|
    v_add_f32 v42, v42, |v136|
    v_add_f32 v42, v42, |v121|
    v_add_f32 v42, v42, |v137|
    v_mov_b32 v44, 0x7e800000
    v_cmp_nlt_f32 vcc, v42, v44
    s_nop 0
    v_mov_b32 v44, 0x5f800000
    v_cmp_nlt_f32 s[68:69], v124, v44
    v_cmp_nlt_f32 s[70:71], v140, v44
    s_or_b64 vcc, vcc, s[68:69]
    s_or_b64 vcc, vcc, s[70:71]
    s_cbranch_vccz L_a_ok
    s_mov_b32 s65, 16
    v_mov_b32_e64 v9, 0
    v_mov_b32 v40, 0xff800000
    v_mov_b32 v41, 0xff800000
    s_mov_b32 s66, 32
L_a_mloop:
    s_nop 0
    ds_read_b128 v[16:19], v37 offset:0
    ds_read_b32 v24, v38 offset:1024
    v_add_u32 v37, 2368, v37
    v_add_u32 v38, 2368, v38
    s_waitcnt lgkmcnt(0)
    s_nop 0
    v_mfma_f32_32x32x4_2b_bf16 v[48:79], v[24:25], v[8:9], 0
    s_nop 15
    s_nop 1
    v_mfma_f32_32x32x16_bf16 v[48:63], v[16:19], v[4:7], v[48:63]
    v_mfma_f32_32x32x16_bf16 v[64:79], v[16:19], v[12:15], v[64:79]
    s_nop 11
    s_nop 0
    v_max3_f32 v40, v40, v48, v49
    v_max3_f32 v40, v40, v50, v51
    v_max3_f32 v40, v40, v52, v53
    v_max3_f32 v40, v40, v54, v55
    v_max3_f32 v40, v40, v56, v57
    v_max3_f32 v40, v40, v58, v59
    v_max3_f32 v40, v40, v60, v61
    v_max3_f32 v40, v40, v62, v63
    v_max3_f32 v41, v41, v64, v65
    v_max3_f32 v41, v41, v66, v67
    v_max3_f32 v41, v41, v68, v69
    v_max3_f32 v41, v41, v70, v71
    v_max3_f32 v41, v41, v72, v73
    v_max3_f32 v41, v41, v74, v75
    v_max3_f32 v41, v41, v76, v77
    v_max3_f32 v41, v41, v78, v79
    s_sub_u32 s66, s66, 1
    s_cmp_lg_u32 s66, 0
    s_cbranch_scc1 L_a_mloop
    s_nop 0
    v_subrev_u32 v37, 75776, v37
    v_subrev_u32 v38, 75776, v38
    v_mov_b32 v42, v40
    v_mov_b32 v43, v41
    s_nop 1
    v_permlane32_swap_b32 v40, v42
    v_permlane32_swap_b32 v41, v43
    v_cmp_gt_u32 vcc, 32, v0
    v_max_f32_e64 v40, v40, v42
    v_cvt_pk_bf16_f32 v42, -v40, 0
    v_lshlrev_b32 v40, 16, v42
    v_max_f32 v41, v41, v43
    v_cvt_pk_bf16_f32 v43, -v41, 0
    v_lshlrev_b32 v41, 16, v43
    v_cndmask_b32 v9, v43, v42, vcc
    v_mov_b32 v112, 0
    v_mov_b32 v128, 0
    v_mov_b32 v113, 0
    v_mov_b32 v129, 0
    v_mov_b32 v114, 0
    v_mov_b32 v130, 0
    v_mov_b32 v115, 0
    v_mov_b32 v131, 0
    v_mov_b32 v116, 0
    v_mov_b32 v132, 0
    v_mov_b32 v117, 0
    v_mov_b32 v133, 0
    v_mov_b32 v118, 0
    v_mov_b32 v134, 0
    v_mov_b32 v119, 0
    v_mov_b32 v135, 0
    v_mov_b32 v120, 0
    v_mov_b32 v136, 0
    v_mov_b32 v121, 0
    v_mov_b32 v137, 0
    v_mov_b32 v122, 0
    v_mov_b32 v138, 0
    v_mov_b32 v123, 0
    v_mov_b32 v139, 0
    v_mov_b32 v124, 0
    v_mov_b32 v140, 0
    v_mov_b32 v125, 0
    v_mov_b32 v141, 0
    v_mov_b32 v126, 0
    v_mov_b32 v142, 0
    v_mov_b32 v127, 0
    v_mov_b32 v143, 0
    v_mov_b32 v104, 0
    v_mov_b32 v105, 0
    v_mov_b32 v106, 0
    v_mov_b32 v107, 0
    v_mov_b32 v108, 0
    v_mov_b32 v109, 0
    v_mov_b32 v110, 0
    v_mov_b32 v111, 0
    v_mov_b32 v32, 0
    v_mov_b32 v33, 0
    v_mov_b32 v34, 0
    v_mov_b32 v35, 0
    s_branch L_a_restart
L_a_ok:
    s_setprio 0
    v_mov_b32 v2, v144
    s_lshl_b32 s60, s3, 2
    v_add_u32 v145, s60, v144
    s_xor_b32 s60, s60, 16
    v_add_u32 v147, s60, v144
    v_mov_b32 v146, 1
    ds_write_b32 v145, v146 offset:256
    ds_read_b32 v16, v2 offset:416
    s_waitcnt lgkmcnt(0)
    v_readfirstlane_b32 s74, v16
    s_mul_i32 s73, s6, 18432
    s_add_u32 s73, s73, s18
    s_cmp_eq_u32 s7, 1
    s_cbranch_scc0 L_a_exch
    s_mov_b32 s44, s16
    s_and_b32 s45, s17, 0xffff
    s_mov_b32 s46, 663552
    s_mov_b32 s47, 0x00020000
    s_mov_b32 s48, s8
    s_nop 0
    s_and_b32 s49, s9, 0xffff
    s_mov_b32 s50, 2359296
    s_mov_b32 s51, 0x00020000
    v_swap_b32 v112, v128
    v_swap_b32 v113, v129
    v_swap_b32 v114, v130
    v_swap_b32 v115, v131
    v_swap_b32 v116, v132
    v_swap_b32 v117, v133
    v_swap_b32 v118, v134
    v_swap_b32 v119, v135
    v_swap_b32 v120, v136
    v_swap_b32 v121, v137
    v_swap_b32 v124, v140
    v_swap_b32 v40, v41
    s_lshl_b32 s60, s4, 8
    s_lshl_b32 s61, s6, 6
    s_add_u32 s60, s60, s61
    s_nop 0
    s_add_u32 s60, s60, 2621440
    buffer_load_dword v158, v163, s[40:43], s60 offen
    s_lshl_b32 s62, s6, 10
    s_cmp_eq_u32 s74, 1
    s_cbranch_scc0 L_a_ntouch
    s_nop 0
    s_mul_i32 s60, s5, 9216
    s_add_u32 s60, s60, s18
    s_nop 0
    s_add_u32 s60, s60, 7602176
    s_mul_i32 s61, s6, 2304
    s_add_u32 s60, s60, s61
    v_cmp_gt_u32 vcc, 18, v0
    v_lshlrev_b32_e64 v16, 7, v0
    s_nop 0
    v_cndmask_b32 v16, v3, v16, vcc
    buffer_load_dword v20, v16, s[40:43], s60 offen sc1
L_a_ntouch:
    s_mov_b32 s66, 160000
L_lw10:
    ds_read_b128 v[16:19], v2 offset:272
    s_waitcnt lgkmcnt(0)
    v_min_u32 v16, v16, v17
    v_min3_u32 v16, v16, v18, v19
    v_cmp_gt_u32 vcc, 1, v16
    s_cbranch_vccz L_lw10_ok
    s_sleep 4
    s_sub_u32 s66, s66, 1
    s_cmp_lg_u32 s66, 0
    s_cbranch_scc1 L_lw10
L_lw10_ok:
    s_add_u32 s60, s62, 75776
    s_mov_b32 m0, s60
    s_mov_b32 s61, 0
    buffer_load_dwordx4 v148, s[44:47], s61 offen lds
    s_add_u32 s60, s62, 79872
    s_mov_b32 m0, s60
    s_mov_b32 s61, 0
    buffer_load_dwordx4 v149, s[44:47], s61 offen lds
    s_cmp_eq_u32 s6, 0
    s_cbranch_scc0 L_wo11
    s_mov_b32 m0, 83968
    s_nop 0
    s_nop 0
    buffer_load_dwordx4 v150, s[44:47], s61 offen lds
L_wo11:
    s_waitcnt vmcnt(3)
    s_nop 0
    s_add_u32 s60, s62, 84992
    s_mov_b32 m0, s60
    s_nop 0
    s_mov_b32 s61, 82944
    buffer_load_dwordx4 v148, s[44:47], s61 offen lds
    s_add_u32 s60, s62, 89088
    s_mov_b32 m0, s60
    s_nop 0
    s_mov_b32 s61, 82944
    buffer_load_dwordx4 v149, s[44:47], s61 offen lds
    s_cmp_eq_u32 s6, 1
    s_cbranch_scc0 L_wo12
    s_mov_b32 m0, 93184
    s_nop 0
    s_nop 0
    buffer_load_dwordx4 v150, s[44:47], s61 offen lds
L_wo12:
    s_waitcnt vmcnt(3)
    s_nop 0
    s_add_u32 s60, s62, 94208
    s_mov_b32 m0, s60
    s_nop 0
    s_mov_b32 s61, 165888
    buffer_load_dwordx4 v148, s[44:47], s61 offen lds
    s_add_u32 s60, s62, 98304
    s_mov_b32 m0, s60
    s_nop 0
    s_mov_b32 s61, 165888
    buffer_load_dwordx4 v149, s[44:47], s61 offen lds
    s_cmp_eq_u32 s6, 2
    s_cbranch_scc0 L_wo13
    s_mov_b32 m0, 102400
    s_nop 0
    s_nop 0
    buffer_load_dwordx4 v150, s[44:47], s61 offen lds
L_wo13:
    s_waitcnt vmcnt(3)
    s_nop 0
    s_add_u32 s60, s62, 103424
    s_mov_b32 m0, s60
    s_nop 0
    s_mov_b32 s61, 248832
    buffer_load_dwordx4 v148, s[44:47], s61 offen lds
    s_add_u32 s60, s62, 107520
    s_mov_b32 m0, s60
    s_nop 0
    s_mov_b32 s61, 248832
    buffer_load_dwordx4 v149, s[44:47], s61 offen lds
    s_cmp_eq_u32 s6, 3
    s_cbranch_scc0 L_wo14
    s_mov_b32 m0, 111616
    s_nop 0
    s_nop 0
    buffer_load_dwordx4 v150, s[44:47], s61 offen lds
L_wo14:
    s_waitcnt vmcnt(3)
    s_nop 0
    s_add_u32 s60, s62, 112640
    s_mov_b32 m0, s60
    s_nop 0
    s_mov_b32 s61, 331776
    buffer_load_dwordx4 v148, s[44:47], s61 offen lds
    s_add_u32 s60, s62, 116736
    s_mov_b32 m0, s60
    s_nop 0
    s_mov_b32 s61, 331776
    buffer_load_dwordx4 v149, s[44:47], s61 offen lds
    s_cmp_eq_u32 s6, 0
    s_cbranch_scc0 L_wo15
    s_mov_b32 m0, 120832
    s_nop 0
    s_nop 0
    buffer_load_dwordx4 v150, s[44:47], s61 offen lds
L_wo15:
    s_waitcnt vmcnt(3)
    s_nop 0
    s_add_u32 s60, s62, 121856
    s_mov_b32 m0, s60
    s_nop 0
    s_mov_b32 s61, 414720
    buffer_load_dwordx4 v148, s[44:47], s61 offen lds
    s_add_u32 s60, s62, 125952
    s_mov_b32 m0, s60
    s_nop 0
    s_mov_b32 s61, 414720
    buffer_load_dwordx4 v149, s[44:47], s61 offen lds
    s_cmp_eq_u32 s6, 1
    s_cbranch_scc0 L_wo16
    s_mov_b32 m0, 130048
    s_nop 0
    s_nop 0
    buffer_load_dwordx4 v150, s[44:47], s61 offen lds
L_wo16:
    s_waitcnt vmcnt(3)
    s_nop 0
    s_add_u32 s60, s62, 131072
    s_mov_b32 m0, s60
    s_nop 0
    s_mov_b32 s61, 497664
    buffer_load_dwordx4 v148, s[44:47], s61 offen lds
    s_add_u32 s60, s62, 135168
    s_mov_b32 m0, s60
    s_nop 0
    s_mov_b32 s61, 497664
    buffer_load_dwordx4 v149, s[44:47], s61 offen lds
    s_cmp_eq_u32 s6, 2
    s_cbranch_scc0 L_wo17
    s_mov_b32 m0, 139264
    s_nop 0
    s_nop 0
    buffer_load_dwordx4 v150, s[44:47], s61 offen lds
L_wo17:
    s_waitcnt vmcnt(3)
    s_nop 0
    s_add_u32 s60, s62, 140288
    s_mov_b32 m0, s60
    s_nop 0
    s_mov_b32 s61, 580608
    buffer_load_dwordx4 v148, s[44:47], s61 offen lds
    s_add_u32 s60, s62, 144384
    s_mov_b32 m0, s60
    s_nop 0
    s_mov_b32 s61, 580608
    buffer_load_dwordx4 v149, s[44:47], s61 offen lds
    s_cmp_eq_u32 s6, 3
    s_cbranch_scc0 L_wo18
    s_mov_b32 m0, 148480
    s_nop 0
    s_nop 0
    buffer_load_dwordx4 v150, s[44:47], s61 offen lds
L_wo18:
    s_waitcnt vmcnt(3)
    s_nop 0
    buffer_load_dwordx4 v[96:99], v151, s[44:47], 0 offen
    buffer_load_dwordx4 v[100:103], v152, s[44:47], 0 offen
    buffer_load_dwordx4 v[104:107], v153, s[44:47], 0 offen
    v_add_u32_e64 v108, s62, v1
    v_add_u32 v108, 49152, v108
    v_add_u32 v109, 57344, v1
    buffer_load_dwordx2 v[148:149], v162, s[48:51], s73 offen offset:0
    buffer_load_dwordx2 v[150:151], v162, s[48:51], s73 offen offset:32
    buffer_load_dwordx2 v[152:153], v162, s[48:51], s73 offen offset:64
    buffer_load_dwordx2 v[154:155], v162, s[48:51], s73 offen offset:96
    buffer_load_dwordx2 v[156:157], v162, s[48:51], s73 offen offset:128
    s_waitcnt vmcnt(5)
    s_nop 0
    ds_write_b32 v145, v146 offset:336
L_a_exch:
    s_mul_i32 s60, s3, 3072
    s_add_u32 s60, s60, 0
    s_xor_b32 s61, s3, 4
    s_mul_i32 s61, s61, 3072
    s_add_u32 s61, s61, 0
    v_add_u32 v42, s60, v1
    v_add_u32 v43, s61, v1
    v_mov_b32 v138, v140
    v_mov_b32_e64 v139, v41
    s_mul_i32 s60, s7, 36864
    s_add_u32 s60, s60, s18
    s_nop 0
    s_add_u32 s60, s60, 7602176
    s_lshr_b32 s61, s64, 1
    s_lshl_b32 s61, s61, 10
    s_and_b32 s62, s64, 1
    s_lshl_b32 s62, s62, 9
    s_add_u32 s61, s61, s62
    s_add_u32 s61, s61, s60
    v_bfe_u32 v44, v0, 4, 1
    v_mul_u32_u24 v44, 18432, v44
    v_and_b32_e64 v45, 15, v0
    v_lshl_add_u32 v44, v45, 4, v44
    v_lshrrev_b32_e64 v45, 5, v0
    v_lshl_add_u32 v45, v45, 8, v44
    v_cmp_gt_u32 vcc, 32, v0
    s_lshr_b32 s62, s64, 4
    s_add_u32 s62, s62, 16
    s_lshl_b32 s62, s62, 10
    v_cndmask_b32 v44, v3, v44, vcc
    s_nop 0
    s_bfe_u32 s63, s64, 0x20002
    s_lshl_b32 s63, s63, 8
    s_add_u32 s62, s62, s63
    s_and_b32 s63, s64, 3
    s_lshl_b32 s63, s63, 2
    s_add_u32 s62, s62, s63
    s_add_u32 s62, s62, s60
    s_mul_i32 s60, s7, 41472
    v_lshrrev_b32 v10, 4, v0
    v_lshlrev_b32 v10, 3, v10
    v_bfe_u32 v11, v0, 2, 2
    v_lshl_add_u32 v10, v11, 1, v10
    v_mul_u32_u24 v10, 144, v10
    v_and_b32_e64 v11, 3, v0
    v_lshl_add_u32 v10, v11, 3, v10
    v_add_u32 v10, 75776, v10
    v_add_u32 v14, s60, v10
    s_cmp_eq_u32 s7, 1
    s_mov_b32 s60, 32256
    s_cselect_b32 s60, 4294899200, s60
    v_add_u32_e64 v15, s60, v14
    s_mov_b32 s66, 160000
L_lw19:
    ds_read_b128 v[16:19], v2 offset:256
    s_waitcnt lgkmcnt(0)
    v_min_u32 v16, v16, v17
    v_min3_u32 v16, v16, v18, v19
    v_cmp_gt_u32 vcc, 1, v16
    s_cbranch_vccz L_lw19_ok
    s_sleep 2
    s_sub_u32 s66, s66, 1
    s_cmp_lg_u32 s66, 0
    s_cbranch_scc1 L_lw19
L_lw19_ok:
    ds_write_b128 v42, v[128:131]
    ds_write_b128 v42, v[132:135] offset:1024
    ds_write_b128 v42, v[136:139] offset:2048
    s_waitcnt lgkmcnt(0)
    s_nop 0
    ds_write_b32 v145, v146 offset:288
    s_cmp_eq_u32 s7, 1
    s_cbranch_scc0 L_a_nw8
    ds_write_b128 v108, v[96:99]
    ds_write_b128 v108, v[100:103] offset:4096
    ds_write_b128 v109, v[104:107]
L_a_nw8:
    s_mov_b32 s66, 160000
L_lw20:
    ds_read_b32 v16, v147 offset:288
    s_waitcnt lgkmcnt(0)
    v_cmp_gt_u32 vcc, 1, v16
    s_cbranch_vccz L_lw20_ok
    s_sub_u32 s66, s66, 1
    s_cmp_lg_u32 s66, 0
    s_cbranch_scc1 L_lw20
L_lw20_ok:
    ds_read_b128 v[136:139], v43 offset:2048
    ds_read_b128 v[128:131], v43
    ds_read_b128 v[132:135], v43 offset:1024
    s_waitcnt lgkmcnt(2)
    v_min_f32 v16, v40, v139
    v_sub_f32 v17, v16, v40
    v_sub_f32 v16, v16, v139
    v_exp_f32 v17, v17
    v_exp_f32 v16, v16
    s_nop 0
    v_mul_f32 v18, v17, v124
    v_fmac_f32 v18, v16, v138
    v_rcp_f32 v18, v18
    s_nop 0
    v_mul_f32 v17, v17, v18
    v_mul_f32 v16, v16, v18
    s_waitcnt lgkmcnt(0)
    v_mul_f32 v112, v112, v17
    v_fmac_f32 v112, v128, v16
    v_mul_f32 v113, v113, v17
    v_fmac_f32 v113, v129, v16
    v_mul_f32 v114, v114, v17
    v_fmac_f32 v114, v130, v16
    v_mul_f32 v115, v115, v17
    v_fmac_f32 v115, v131, v16
    v_mul_f32 v116, v116, v17
    v_fmac_f32 v116, v132, v16
    v_mul_f32 v117, v117, v17
    v_fmac_f32 v117, v133, v16
    v_mul_f32 v118, v118, v17
    v_fmac_f32 v118, v134, v16
    v_mul_f32 v119, v119, v17
    v_fmac_f32 v119, v135, v16
    v_mul_f32 v120, v120, v17
    v_fmac_f32 v120, v136, v16
    v_mul_f32 v121, v121, v17
    v_fmac_f32 v121, v137, v16
    v_cvt_pk_bf16_f32 v4, v112, v113
    v_cvt_pk_bf16_f32 v5, v114, v115
    v_cvt_pk_bf16_f32 v6, v116, v117
    v_cvt_pk_bf16_f32 v7, v118, v119
    v_cvt_pk_bf16_f32 v8, v120, v121
    s_cmp_eq_u32 s74, 1
    s_cbranch_scc1 L_a_ofast
    buffer_store_dwordx4 v[4:7], v45, s[40:43], s61 offen sc1
    buffer_store_dword v8, v44, s[40:43], s62 offen sc1
    s_branch L_a_ost
L_a_ofast:
    s_nop 0
    buffer_store_dwordx4 v[4:7], v45, s[40:43], s61 offen
    buffer_store_dword v8, v44, s[40:43], s62 offen
L_a_ost:
    v_mov_b32 v12, v145
    v_mov_b32 v13, 1
    v_mov_b32 v11, v147
    s_waitcnt vmcnt(0)
    ds_write_b32 v12, v13 offset:320
    s_cmp_eq_u32 s3, 4
    s_cbranch_scc0 L_a_ns4
    s_mov_b32 s66, 160000
L_lw21:
    ds_read_b128 v[16:19], v2 offset:320
    s_waitcnt lgkmcnt(0)
    v_min_u32 v16, v16, v17
    v_min3_u32 v16, v16, v18, v19
    v_cmp_gt_u32 vcc, 1, v16
    s_cbranch_vccz L_lw21_ok
    s_sub_u32 s66, s66, 1
    s_cmp_lg_u32 s66, 0
    s_cbranch_scc1 L_lw21
L_lw21_ok:
    s_nop 0
    s_mov_b32 s66, 160000
L_lw22:
    ds_read_b128 v[16:19], v2 offset:336
    s_waitcnt lgkmcnt(0)
    v_min_u32 v16, v16, v17
    v_min3_u32 v16, v16, v18, v19
    v_cmp_gt_u32 vcc, 1, v16
    s_cbranch_vccz L_lw22_ok
    s_sub_u32 s66, s66, 1
    s_cmp_lg_u32 s66, 0
    s_cbranch_scc1 L_lw22
L_lw22_ok:
    s_lshl_b32 s60, s4, 7
    s_lshl_b32 s61, s5, 2
    s_add_u32 s61, s61, s60
    s_add_u32 s61, s61, 204800
    v_cmp_eq_u32 vcc, 0, v0
    v_mov_b32 v16, 0
    v_bfe_u32 v17, v0, 1, 2
    v_cndmask_b32 v16, v3, v16, vcc
    s_cmp_eq_u32 s74, 1
    s_cbranch_scc1 L_a_ffast
    s_nop 0
    buffer_store_dword v13, v16, s[40:43], s61 offen sc1
    s_branch L_a_fst
L_a_ffast:
    s_nop 0
    buffer_store_dword v13, v16, s[40:43], s61 offen
L_a_fst:
    v_and_b32 v17, 1, v0
    v_lshlrev_b32 v17, 4, v17
    s_add_u32 s60, s60, 204800
    s_mov_b32 s76, s60
    v_mov_b32 v9, v17
L_a_ns4:
    s_mov_b32 s66, 160000
L_lw23:
    ds_read_b128 v[16:19], v2 offset:352
    s_waitcnt lgkmcnt(0)
    v_min_u32 v16, v16, v17
    v_min3_u32 v16, v16, v18, v19
    v_cmp_gt_u32 vcc, 1, v16
    s_cbranch_vccz L_lw23_ok
    s_sleep 1
    s_sub_u32 s66, s66, 1
    s_cmp_lg_u32 s66, 0
    s_cbranch_scc1 L_lw23
L_lw23_ok:
    ds_read_b64_tr_b16 v[72:73], v14 offset:0
    ds_read_b64_tr_b16 v[74:75], v14 offset:144
    ds_read_b64_tr_b16 v[76:77], v14 offset:32
    ds_read_b64_tr_b16 v[78:79], v14 offset:176
    ds_read_b64_tr_b16 v[80:81], v14 offset:64
    ds_read_b64_tr_b16 v[82:83], v14 offset:208
    ds_read_b64_tr_b16 v[84:85], v14 offset:96
    ds_read_b64_tr_b16 v[86:87], v14 offset:240
    ds_read_b64_tr_b16 v[88:89], v14 offset:128
    ds_read_b64_tr_b16 v[90:91], v14 offset:272
    ds_read_b64_tr_b16 v[92:93], v14 offset:4608
    ds_read_b64_tr_b16 v[94:95], v14 offset:4752
    s_waitcnt lgkmcnt(4)
    s_nop 0
    ds_read_b64_tr_b16 v[96:97], v14 offset:4640
    ds_read_b64_tr_b16 v[98:99], v14 offset:4784
    ds_read_b64_tr_b16 v[100:101], v14 offset:4672
    ds_read_b64_tr_b16 v[102:103], v14 offset:4816
    ds_read_b64_tr_b16 v[104:105], v14 offset:4704
    ds_read_b64_tr_b16 v[106:107], v14 offset:4848
    ds_read_b64_tr_b16 v[108:109], v14 offset:4736
    ds_read_b64_tr_b16 v[110:111], v14 offset:4880
    ds_read_b64_tr_b16 v[112:113], v14 offset:9216
    ds_read_b64_tr_b16 v[114:115], v14 offset:9360
    ds_read_b64_tr_b16 v[116:117], v14 offset:9248
    ds_read_b64_tr_b16 v[118:119], v14 offset:9392
    s_waitcnt lgkmcnt(4)
    s_nop 0
    ds_read_b64_tr_b16 v[120:121], v14 offset:9280
    ds_read_b64_tr_b16 v[122:123], v14 offset:9424
    ds_read_b64_tr_b16 v[124:125], v14 offset:9312
    ds_read_b64_tr_b16 v[126:127], v14 offset:9456
    ds_read_b64_tr_b16 v[128:129], v14 offset:9344
    ds_read_b64_tr_b16 v[130:131], v14 offset:9488
    ds_read_b64_tr_b16 v[132:133], v14 offset:13824
    ds_read_b64_tr_b16 v[134:135], v14 offset:13968
    ds_read_b64_tr_b16 v[136:137], v14 offset:13856
    ds_read_b64_tr_b16 v[138:139], v14 offset:14000
    ds_read_b64_tr_b16 v[140:141], v14 offset:13888
    ds_read_b64_tr_b16 v[142:143], v14 offset:14032
    s_waitcnt lgkmcnt(4)
    s_waitcnt lgkmcnt(0)
    s_cmp_eq_u32 s3, 4
    s_cbranch_scc0 L_a_tw
    s_mov_b32 s66, 20000
L_a_opoll:
    buffer_load_dwordx4 v[20:23], v9, s[40:43], s76 offen sc1
    s_waitcnt vmcnt(0)
    v_and_b32 v20, v20, v21
    v_and_b32_e64 v22, v22, v23
    v_and_b32 v20, v20, v22
    v_cmp_ne_u32 vcc, 1, v20
    s_cbranch_vccz L_a_ook
    s_sub_u32 s66, s66, 1
    s_cmp_lg_u32 s66, 0
    s_cbranch_scc1 L_a_opoll
L_a_ook:
    ds_write_b32 v2, v13 offset:368
L_a_tw:
    s_mul_i32 s60, s7, 9216
    s_add_u32 s60, s60, s73
    s_nop 0
    s_add_u32 s60, s60, 7602176
    s_add_u32 s61, s60, 4096
    s_add_u32 s62, s60, 8192
    s_mul_i32 s63, s6, 5120
    s_add_u32 s63, s63, 0
    v_add_u32 v10, s63, v1
    s_cmp_eq_u32 s7, 1
    s_cbranch_scc0 L_a_np2
    s_setprio 1
L_a_np2:
    s_nop 0
    s_mov_b32 s66, 160000
L_lw24:
    ds_read_b32 v16, v2 offset:368
    s_waitcnt lgkmcnt(0)
    v_cmp_gt_u32 vcc, 1, v16
    s_cbranch_vccz L_lw24_ok
    s_sleep 1
    s_sub_u32 s66, s66, 1
    s_cmp_lg_u32 s66, 0
    s_cbranch_scc1 L_lw24
L_lw24_ok:
    s_nop 0
    buffer_load_dwordx4 v[36:39], v1, s[40:43], s60 offen offset:0
    buffer_load_dwordx4 v[40:43], v1, s[40:43], s60 offen offset:1024
    buffer_load_dwordx4 v[44:47], v1, s[40:43], s60 offen offset:2048
    buffer_load_dwordx4 v[48:51], v1, s[40:43], s60 offen offset:3072
    buffer_load_dwordx4 v[52:55], v1, s[40:43], s61 offen offset:0
    buffer_load_dwordx4 v[56:59], v1, s[40:43], s61 offen offset:1024
    buffer_load_dwordx4 v[60:63], v1, s[40:43], s61 offen offset:2048
    buffer_load_dwordx4 v[64:67], v1, s[40:43], s61 offen offset:3072
    buffer_load_dwordx4 v[68:71], v1, s[40:43], s62 offen offset:0
    ds_read_b64_tr_b16 v[144:145], v14 offset:13920
    ds_read_b64_tr_b16 v[146:147], v14 offset:14064
    s_waitcnt vmcnt(8)
    s_nop 0
    v_mfma_f32_16x16x32_bf16 v[16:19], v[72:75], v[36:39], 0
    ds_read_b64_tr_b16 v[72:73], v14 offset:13952
    ds_read_b64_tr_b16 v[74:75], v14 offset:14096
    v_mfma_f32_16x16x32_bf16 v[20:23], v[76:79], v[36:39], 0
    ds_read_b64_tr_b16 v[76:77], v14 offset:18432
    ds_read_b64_tr_b16 v[78:79], v14 offset:18576
    v_mfma_f32_16x16x32_bf16 v[24:27], v[80:83], v[36:39], 0
    ds_read_b64_tr_b16 v[80:81], v14 offset:18464
    ds_read_b64_tr_b16 v[82:83], v14 offset:18608
    v_mfma_f32_16x16x32_bf16 v[28:31], v[84:87], v[36:39], 0
    ds_read_b64_tr_b16 v[84:85], v14 offset:18496
    ds_read_b64_tr_b16 v[86:87], v14 offset:18640
    v_mfma_f32_16x16x32_bf16 v[32:35], v[88:91], v[36:39], 0
    ds_read_b64_tr_b16 v[88:89], v14 offset:18528
    ds_read_b64_tr_b16 v[90:91], v14 offset:18672
    s_waitcnt vmcnt(7)
    s_nop 0
    v_mfma_f32_16x16x32_bf16 v[16:19], v[92:95], v[40:43], v[16:19]
    ds_read_b64_tr_b16 v[92:93], v14 offset:18560
    ds_read_b64_tr_b16 v[94:95], v14 offset:18704
    v_mfma_f32_16x16x32_bf16 v[20:23], v[96:99], v[40:43], v[20:23]
    ds_read_b64_tr_b16 v[96:97], v14 offset:23040
    ds_read_b64_tr_b16 v[98:99], v14 offset:23184
    v_mfma_f32_16x16x32_bf16 v[24:27], v[100:103], v[40:43], v[24:27]
    ds_read_b64_tr_b16 v[100:101], v14 offset:23072
    ds_read_b64_tr_b16 v[102:103], v14 offset:23216
    v_mfma_f32_16x16x32_bf16 v[28:31], v[104:107], v[40:43], v[28:31]
    ds_read_b64_tr_b16 v[104:105], v14 offset:23104
    ds_read_b64_tr_b16 v[106:107], v14 offset:23248
    v_mfma_f32_16x16x32_bf16 v[32:35], v[108:111], v[40:43], v[32:35]
    ds_read_b64_tr_b16 v[108:109], v14 offset:23136
    ds_read_b64_tr_b16 v[110:111], v14 offset:23280
    s_waitcnt vmcnt(6)
    s_nop 0
    v_mfma_f32_16x16x32_bf16 v[16:19], v[112:115], v[44:47], v[16:19]
    ds_read_b64_tr_b16 v[112:113], v14 offset:23168
    ds_read_b64_tr_b16 v[114:115], v14 offset:23312
    v_mfma_f32_16x16x32_bf16 v[20:23], v[116:119], v[44:47], v[20:23]
    ds_read_b64_tr_b16 v[116:117], v14 offset:27648
    ds_read_b64_tr_b16 v[118:119], v14 offset:27792
    v_mfma_f32_16x16x32_bf16 v[24:27], v[120:123], v[44:47], v[24:27]
    ds_read_b64_tr_b16 v[120:121], v14 offset:27680
    ds_read_b64_tr_b16 v[122:123], v14 offset:27824
    v_mfma_f32_16x16x32_bf16 v[28:31], v[124:127], v[44:47], v[28:31]
    ds_read_b64_tr_b16 v[124:125], v14 offset:27712
    ds_read_b64_tr_b16 v[126:127], v14 offset:27856
    v_mfma_f32_16x16x32_bf16 v[32:35], v[128:131], v[44:47], v[32:35]
    ds_read_b64_tr_b16 v[128:129], v14 offset:27744
    ds_read_b64_tr_b16 v[130:131], v14 offset:27888
    s_waitcnt vmcnt(5)
    s_nop 0
    v_mfma_f32_16x16x32_bf16 v[16:19], v[132:135], v[48:51], v[16:19]
    ds_read_b64_tr_b16 v[132:133], v14 offset:27776
    ds_read_b64_tr_b16 v[134:135], v14 offset:27920
    v_mfma_f32_16x16x32_bf16 v[20:23], v[136:139], v[48:51], v[20:23]
    ds_read_b64_tr_b16 v[136:137], v15 offset:0
    ds_read_b64_tr_b16 v[138:139], v15 offset:144
    v_mfma_f32_16x16x32_bf16 v[24:27], v[140:143], v[48:51], v[24:27]
    ds_read_b64_tr_b16 v[140:141], v15 offset:32
    ds_read_b64_tr_b16 v[142:143], v15 offset:176
    s_waitcnt lgkmcnt(12)
    s_nop 0
    v_mfma_f32_16x16x32_bf16 v[28:31], v[144:147], v[48:51], v[28:31]
    ds_read_b64_tr_b16 v[144:145], v15 offset:64
    ds_read_b64_tr_b16 v[146:147], v15 offset:208
    s_waitcnt lgkmcnt(12)
    s_nop 0
    v_mfma_f32_16x16x32_bf16 v[32:35], v[72:75], v[48:51], v[32:35]
    ds_read_b64_tr_b16 v[72:73], v15 offset:96
    ds_read_b64_tr_b16 v[74:75], v15 offset:240
    s_waitcnt vmcnt(4)
    s_waitcnt lgkmcnt(12)
    v_mfma_f32_16x16x32_bf16 v[16:19], v[76:79], v[52:55], v[16:19]
    ds_read_b64_tr_b16 v[76:77], v15 offset:128
    ds_read_b64_tr_b16 v[78:79], v15 offset:272
    s_waitcnt lgkmcnt(12)
    s_nop 0
    v_mfma_f32_16x16x32_bf16 v[20:23], v[80:83], v[52:55], v[20:23]
    ds_read_b64_tr_b16 v[80:81], v15 offset:4608
    ds_read_b64_tr_b16 v[82:83], v15 offset:4752
    s_waitcnt lgkmcnt(12)
    s_nop 0
    v_mfma_f32_16x16x32_bf16 v[24:27], v[84:87], v[52:55], v[24:27]
    ds_read_b64_tr_b16 v[84:85], v15 offset:4640
    ds_read_b64_tr_b16 v[86:87], v15 offset:4784
    s_waitcnt lgkmcnt(12)
    s_nop 0
    v_mfma_f32_16x16x32_bf16 v[28:31], v[88:91], v[52:55], v[28:31]
    ds_read_b64_tr_b16 v[88:89], v15 offset:4672
    ds_read_b64_tr_b16 v[90:91], v15 offset:4816
    s_waitcnt lgkmcnt(12)
    s_nop 0
    v_mfma_f32_16x16x32_bf16 v[32:35], v[92:95], v[52:55], v[32:35]
    ds_read_b64_tr_b16 v[92:93], v15 offset:4704
    ds_read_b64_tr_b16 v[94:95], v15 offset:4848
    s_waitcnt vmcnt(3)
    s_waitcnt lgkmcnt(12)
    v_mfma_f32_16x16x32_bf16 v[16:19], v[96:99], v[56:59], v[16:19]
    ds_read_b64_tr_b16 v[96:97], v15 offset:4736
    ds_read_b64_tr_b16 v[98:99], v15 offset:4880
    s_waitcnt lgkmcnt(12)
    s_nop 0
    v_mfma_f32_16x16x32_bf16 v[20:23], v[100:103], v[56:59], v[20:23]
    s_waitcnt lgkmcnt(12)
    s_nop 0
    v_mfma_f32_16x16x32_bf16 v[24:27], v[104:107], v[56:59], v[24:27]
    s_waitcnt lgkmcnt(12)
    s_nop 0
    v_mfma_f32_16x16x32_bf16 v[28:31], v[108:111], v[56:59], v[28:31]
    s_waitcnt lgkmcnt(12)
    s_nop 0
    v_mfma_f32_16x16x32_bf16 v[32:35], v[112:115], v[56:59], v[32:35]
    s_waitcnt vmcnt(2)
    s_waitcnt lgkmcnt(12)
    v_mfma_f32_16x16x32_bf16 v[16:19], v[116:119], v[60:63], v[16:19]
    s_waitcnt lgkmcnt(12)
    s_nop 0
    v_mfma_f32_16x16x32_bf16 v[20:23], v[120:123], v[60:63], v[20:23]
    s_waitcnt lgkmcnt(12)
    s_nop 0
    v_mfma_f32_16x16x32_bf16 v[24:27], v[124:127], v[60:63], v[24:27]
    s_waitcnt lgkmcnt(12)
    s_nop 0
    v_mfma_f32_16x16x32_bf16 v[28:31], v[128:131], v[60:63], v[28:31]
    s_waitcnt lgkmcnt(12)
    s_nop 0
    v_mfma_f32_16x16x32_bf16 v[32:35], v[132:135], v[60:63], v[32:35]
    s_waitcnt vmcnt(1)
    s_waitcnt lgkmcnt(12)
    v_mfma_f32_16x16x32_bf16 v[16:19], v[136:139], v[64:67], v[16:19]
    s_waitcnt lgkmcnt(12)
    s_nop 0
    v_mfma_f32_16x16x32_bf16 v[20:23], v[140:143], v[64:67], v[20:23]
    s_waitcnt lgkmcnt(12)
    s_nop 0
    v_mfma_f32_16x16x32_bf16 v[24:27], v[144:147], v[64:67], v[24:27]
    s_waitcnt lgkmcnt(12)
    s_nop 0
    v_mfma_f32_16x16x32_bf16 v[28:31], v[72:75], v[64:67], v[28:31]
    s_waitcnt lgkmcnt(10)
    s_nop 0
    v_mfma_f32_16x16x32_bf16 v[32:35], v[76:79], v[64:67], v[32:35]
    s_waitcnt vmcnt(0)
    s_waitcnt lgkmcnt(8)
    v_mfma_f32_16x16x32_bf16 v[16:19], v[80:83], v[68:71], v[16:19]
    s_waitcnt lgkmcnt(6)
    s_nop 0
    v_mfma_f32_16x16x32_bf16 v[20:23], v[84:87], v[68:71], v[20:23]
    s_waitcnt lgkmcnt(4)
    s_nop 0
    v_mfma_f32_16x16x32_bf16 v[24:27], v[88:91], v[68:71], v[24:27]
    s_waitcnt lgkmcnt(2)
    s_nop 0
    v_mfma_f32_16x16x32_bf16 v[28:31], v[92:95], v[68:71], v[28:31]
    s_waitcnt lgkmcnt(0)
    s_nop 0
    v_mfma_f32_16x16x32_bf16 v[32:35], v[96:99], v[68:71], v[32:35]
    s_cmp_eq_u32 s7, 1
    s_cbranch_scc1 L_a_fin
    s_nop 6
    s_nop 0
    ds_write_b128 v10, v[16:19] offset:0
    ds_write_b128 v10, v[20:23] offset:1024
    ds_write_b128 v10, v[24:27] offset:2048
    ds_write_b128 v10, v[28:31] offset:3072
    ds_write_b128 v10, v[32:35] offset:4096
    s_waitcnt lgkmcnt(0)
    s_nop 0
    ds_write_b32 v12, v13 offset:384
    s_endpgm
L_a_fin:
    s_mov_b32 s52, s32
    s_and_b32 s53, s33, 0xffff
    s_mov_b32 s54, 2359296
    s_mov_b32 s55, 0x00020000
    s_mov_b32 s66, 160000
L_lw25:
    ds_read_b32 v4, v2 offset:432
    s_waitcnt lgkmcnt(0)
    v_cmp_gt_u32 vcc, 1, v4
    s_cbranch_vccz L_lw25_ok
    s_sub_u32 s66, s66, 1
    s_cmp_lg_u32 s66, 0
    s_cbranch_scc1 L_lw25
L_lw25_ok:
    ds_read_b64_tr_b16 v[72:73], v166 offset:3072
    ds_read_b64_tr_b16 v[74:75], v166 offset:3584
    ds_read_b64_tr_b16 v[76:77], v166 offset:4096
    ds_read_b64_tr_b16 v[78:79], v166 offset:4608
    ds_read_b64_tr_b16 v[80:81], v166 offset:5120
    v_sub_f32 v9, 1.0, v158
    s_waitcnt lgkmcnt(0)
    v_lshlrev_b32 v84, 16, v148
    v_lshlrev_b32 v8, 16, v72
    v_mul_f32 v84, v84, v9
    v_mul_f32 v84, v84, v8
    v_fmac_f32_e64 v84, v158, v16
    v_and_b32 v85, 0xffff0000, v148
    v_and_b32 v8, 0xffff0000, v72
    v_mul_f32 v85, v85, v9
    v_mul_f32 v85, v85, v8
    v_fmac_f32 v85, v158, v17
    v_lshlrev_b32 v86, 16, v149
    v_lshlrev_b32 v8, 16, v73
    v_mul_f32 v86, v86, v9
    v_mul_f32 v86, v86, v8
    v_fmac_f32 v86, v158, v18
    v_and_b32 v87, 0xffff0000, v149
    v_and_b32 v8, 0xffff0000, v73
    v_mul_f32 v87, v87, v9
    v_mul_f32 v87, v87, v8
    v_fmac_f32 v87, v158, v19
    v_lshlrev_b32 v88, 16, v150
    v_lshlrev_b32 v8, 16, v74
    v_mul_f32 v88, v88, v9
    v_mul_f32 v88, v88, v8
    v_fmac_f32 v88, v158, v20
    v_and_b32 v89, 0xffff0000, v150
    v_and_b32 v8, 0xffff0000, v74
    v_mul_f32 v89, v89, v9
    v_mul_f32 v89, v89, v8
    v_fmac_f32 v89, v158, v21
    v_lshlrev_b32 v90, 16, v151
    v_lshlrev_b32 v8, 16, v75
    v_mul_f32 v90, v90, v9
    v_mul_f32 v90, v90, v8
    v_fmac_f32 v90, v158, v22
    v_and_b32 v91, 0xffff0000, v151
    v_and_b32 v8, 0xffff0000, v75
    v_mul_f32 v91, v91, v9
    v_mul_f32 v91, v91, v8
    v_fmac_f32 v91, v158, v23
    v_lshlrev_b32 v92, 16, v152
    v_lshlrev_b32 v8, 16, v76
    v_mul_f32 v92, v92, v9
    v_mul_f32 v92, v92, v8
    v_fmac_f32 v92, v158, v24
    v_and_b32 v93, 0xffff0000, v152
    v_and_b32 v8, 0xffff0000, v76
    v_mul_f32 v93, v93, v9
    v_mul_f32 v93, v93, v8
    v_fmac_f32 v93, v158, v25
    v_lshlrev_b32 v94, 16, v153
    v_lshlrev_b32 v8, 16, v77
    v_mul_f32 v94, v94, v9
    v_mul_f32 v94, v94, v8
    v_fmac_f32 v94, v158, v26
    v_and_b32 v95, 0xffff0000, v153
    v_and_b32 v8, 0xffff0000, v77
    v_mul_f32 v95, v95, v9
    v_mul_f32 v95, v95, v8
    v_fmac_f32 v95, v158, v27
    v_lshlrev_b32 v96, 16, v154
    v_lshlrev_b32 v8, 16, v78
    v_mul_f32 v96, v96, v9
    v_mul_f32 v96, v96, v8
    v_fmac_f32 v96, v158, v28
    v_and_b32 v97, 0xffff0000, v154
    v_and_b32 v8, 0xffff0000, v78
    v_mul_f32 v97, v97, v9
    v_mul_f32 v97, v97, v8
    v_fmac_f32 v97, v158, v29
    v_lshlrev_b32 v98, 16, v155
    v_lshlrev_b32 v8, 16, v79
    v_mul_f32 v98, v98, v9
    v_mul_f32 v98, v98, v8
    v_fmac_f32 v98, v158, v30
    v_and_b32 v99, 0xffff0000, v155
    v_and_b32 v8, 0xffff0000, v79
    v_mul_f32 v99, v99, v9
    v_mul_f32 v99, v99, v8
    v_fmac_f32 v99, v158, v31
    v_lshlrev_b32 v100, 16, v156
    v_lshlrev_b32 v8, 16, v80
    v_mul_f32 v100, v100, v9
    v_mul_f32 v100, v100, v8
    v_fmac_f32 v100, v158, v32
    v_and_b32 v101, 0xffff0000, v156
    v_and_b32 v8, 0xffff0000, v80
    v_mul_f32 v101, v101, v9
    v_mul_f32 v101, v101, v8
    v_fmac_f32 v101, v158, v33
    v_lshlrev_b32 v102, 16, v157
    v_lshlrev_b32 v8, 16, v81
    v_mul_f32 v102, v102, v9
    v_mul_f32 v102, v102, v8
    v_fmac_f32 v102, v158, v34
    v_and_b32 v103, 0xffff0000, v157
    v_and_b32 v8, 0xffff0000, v81
    v_mul_f32 v103, v103, v9
    v_mul_f32 v103, v103, v8
    v_fmac_f32_e64 v103, v158, v35
    s_mov_b32 s66, 160000
L_lw26:
    ds_read_b32 v4, v11 offset:384
    s_waitcnt lgkmcnt(0)
    v_cmp_gt_u32 vcc, 1, v4
    s_cbranch_vccz L_lw26_ok
    s_sub_u32 s66, s66, 1
    s_cmp_lg_u32 s66, 0
    s_cbranch_scc1 L_lw26
L_lw26_ok:
    ds_read_b128 v[36:39], v10 offset:0
    ds_read_b128 v[40:43], v10 offset:1024
    ds_read_b128 v[44:47], v10 offset:2048
    ds_read_b128 v[48:51], v10 offset:3072
    ds_read_b128 v[52:55], v10 offset:4096
    s_waitcnt lgkmcnt(4)
    v_fmac_f32 v84, v158, v36
    v_fmac_f32 v85, v158, v37
    v_fmac_f32 v86, v158, v38
    v_fmac_f32_e64 v87, v158, v39
    v_cvt_pk_bf16_f32 v84, v84, v85
    v_cvt_pk_bf16_f32 v85, v86, v87
    ds_write_b64 v165, v[84:85] offset:0
    s_waitcnt lgkmcnt(4)
    v_fmac_f32 v88, v158, v40
    v_fmac_f32 v89, v158, v41
    v_fmac_f32 v90, v158, v42
    v_fmac_f32_e64 v91, v158, v43
    v_cvt_pk_bf16_f32 v88, v88, v89
    v_cvt_pk_bf16_f32 v89, v90, v91
    ds_write_b64 v165, v[88:89] offset:32
    s_waitcnt lgkmcnt(4)
    v_fmac_f32 v92, v158, v44
    v_fmac_f32 v93, v158, v45
    v_fmac_f32 v94, v158, v46
    v_fmac_f32_e64 v95, v158, v47
    v_cvt_pk_bf16_f32 v92, v92, v93
    v_cvt_pk_bf16_f32 v93, v94, v95
    ds_write_b64 v165, v[92:93] offset:64
    s_waitcnt lgkmcnt(4)
    v_fmac_f32 v96, v158, v48
    v_fmac_f32 v97, v158, v49
    v_fmac_f32 v98, v158, v50
    v_fmac_f32_e64 v99, v158, v51
    v_cvt_pk_bf16_f32 v96, v96, v97
    v_cvt_pk_bf16_f32 v97, v98, v99
    ds_write_b64 v165, v[96:97] offset:96
    s_waitcnt lgkmcnt(4)
    v_fmac_f32 v100, v158, v52
    v_fmac_f32 v101, v158, v53
    v_fmac_f32 v102, v158, v54
    v_fmac_f32_e64 v103, v158, v55
    v_cvt_pk_bf16_f32 v100, v100, v101
    v_cvt_pk_bf16_f32 v101, v102, v103
    v_cmp_gt_u32 vcc, 32, v0
    s_and_saveexec_b64 s[62:63], vcc
    ds_write_b64 v165, v[100:101] offset:128
    s_mov_b64 exec, s[62:63]
    s_nop 0
    ds_read_b128 v[20:23], v167 offset:0
    ds_read_b128 v[24:27], v167 offset:1024
    ds_read_b128 v[28:31], v167 offset:2048
    s_waitcnt lgkmcnt(2)
    s_nop 0
    buffer_store_dwordx4 v[20:23], v159, s[52:55], s73 offen
    s_waitcnt lgkmcnt(1)
    s_nop 0
    buffer_store_dwordx4 v[24:27], v160, s[52:55], s73 offen
    s_waitcnt lgkmcnt(0)
    s_nop 0
    buffer_store_dwordx4 v[28:31], v161, s[52:55], s73 offen
    s_endpgm
L_a_helper:
    s_setprio 3
    s_mov_b32 s44, s30
    s_nop 0
    s_and_b32 s45, s31, 0xffff
    s_mov_b32 s46, 1152
    s_mov_b32 s47, 0x00020000
    s_barrier
    s_cmp_lt_u32 s5, 6
    s_cbranch_scc1 L_a_wcd
    v_lshlrev_b32 v11, 1, v0
    buffer_load_ushort v20, v11, s[44:47], 0 offen offset:0
    buffer_load_ushort v21, v11, s[44:47], 0 offen offset:128
    buffer_load_ushort v22, v11, s[44:47], 0 offen offset:256
    buffer_load_ushort v23, v11, s[44:47], 0 offen offset:384
    buffer_load_ushort v24, v11, s[44:47], 0 offen offset:512
    buffer_load_ushort v25, v11, s[44:47], 0 offen offset:640
    buffer_load_ushort v26, v11, s[44:47], 0 offen offset:768
    buffer_load_ushort v27, v11, s[44:47], 0 offen offset:896
    buffer_load_ushort v28, v11, s[44:47], 0 offen offset:1024
    v_add_u32 v10, 154112, v1
    s_waitcnt vmcnt(0)
    s_nop 0
    ds_write_b16 v10, v20 offset:0
    ds_write_b16 v10, v21 offset:1024
    ds_write_b16 v10, v22 offset:2048
    ds_write_b16 v10, v23 offset:3072
    ds_write_b16 v10, v24 offset:4096
    ds_write_b16 v10, v25 offset:5120
    ds_write_b16 v10, v26 offset:6144
    ds_write_b16 v10, v27 offset:7168
    ds_write_b16 v10, v28 offset:8192
L_a_wcd:
    s_mov_b32 s40, s36
    s_nop 0
    s_and_b32 s41, s37, 0xffff
    s_mov_b32 s42, 16777216
    s_mov_b32 s43, 0x00020000
    s_mov_b32 s56, s34
    s_nop 0
    s_and_b32 s57, s35, 0xffff
    s_mov_b32 s58, 256
    s_mov_b32 s59, 0x00020000
    v_lshrrev_b32 v15, 4, v0
    v_lshlrev_b32 v15, 3, v15
    v_bfe_u32 v16, v0, 2, 2
    v_add_u32 v15, v15, v16
    v_and_b32 v16, 1, v0
    v_lshlrev_b32_e64 v16, 3, v16
    v_lshl_add_u32 v17, v15, 4, v16
    v_add_u32 v17, 154112, v17
    v_and_b32 v4, 15, v0
    v_lshrrev_b32 v15, 2, v4
    v_sub_u32 v15, 0, v15
    v_lshrrev_b32 v5, 4, v0
    v_xor_b32 v15, v15, v5
    v_and_b32 v15, 3, v15
    v_lshlrev_b32_e64 v15, 4, v15
    v_lshl_add_u32 v16, v4, 6, v15
    s_mul_i32 s60, s6, 18432
    v_add_u32_e64 v16, s60, v16
    s_and_b32 s60, s6, 1
    s_lshl_b32 s60, s60, 4
    v_add_u32 v6, s60, v4
    s_lshl_b32 s64, s4, 1
    s_lshr_b32 s60, s6, 1
    s_add_u32 s64, s64, s60
    s_mul_i32 s64, s64, 2368
    s_add_u32 s64, s64, 0
    v_and_b32 v15, 1, v5
    v_mov_b32 v75, 0
    v_mov_b32 v76, v19
    v_mov_b32 v73, 1
    s_waitcnt lgkmcnt(0)
    s_mov_b32 s66, 160000
L_lw27:
    ds_read_b128 v[60:63], v2 offset:192
    s_waitcnt lgkmcnt(0)
    v_min_u32 v60, v60, v61
    v_min3_u32 v60, v60, v62, v63
    v_cmp_gt_u32 vcc, 1, v60
    s_cbranch_vccz L_lw27_ok
    s_sub_u32 s66, s66, 1
    s_cmp_lg_u32 s66, 0
    s_cbranch_scc1 L_lw27
L_lw27_ok:
    s_waitcnt vmcnt(8)
    ds_read_b128 v[20:23], v16 offset:0
    ds_read_b64_tr_b16 v[40:41], v17 offset:0
    ds_read_b64_tr_b16 v[42:43], v17 offset:64
    s_waitcnt vmcnt(7)
    s_nop 0
    ds_read_b128 v[24:27], v16 offset:1024
    ds_read_b64_tr_b16 v[44:45], v17 offset:512
    ds_read_b64_tr_b16 v[46:47], v17 offset:576
    s_waitcnt vmcnt(6)
    s_nop 0
    ds_read_b128 v[28:31], v16 offset:2048
    ds_read_b64_tr_b16 v[48:49], v17 offset:1024
    ds_read_b64_tr_b16 v[50:51], v17 offset:1088
    s_waitcnt vmcnt(5)
    s_nop 0
    ds_read_b128 v[32:35], v16 offset:3072
    ds_read_b64_tr_b16 v[52:53], v17 offset:1536
    ds_read_b64_tr_b16 v[54:55], v17 offset:1600
    s_waitcnt vmcnt(4)
    s_nop 0
    ds_read_b128 v[36:39], v16 offset:4096
    ds_read_b64_tr_b16 v[56:57], v17 offset:2048
    ds_read_b64_tr_b16 v[58:59], v17 offset:2112
    s_waitcnt lgkmcnt(12)
    s_nop 0
    v_mfma_f32_16x16x32_bf16 v[64:67], v[40:43], v[20:23], 0
    v_mfma_f32_16x16x32_bf16 v[68:71], v[20:23], v[40:43], 0
    s_waitcnt vmcnt(3)
    s_nop 0
    ds_read_b128 v[20:23], v16 offset:5120
    ds_read_b64_tr_b16 v[40:41], v17 offset:2560
    ds_read_b64_tr_b16 v[42:43], v17 offset:2624
    s_waitcnt lgkmcnt(12)
    s_nop 0
    v_mfma_f32_16x16x32_bf16 v[64:67], v[44:47], v[24:27], v[64:67]
    v_mfma_f32_16x16x32_bf16 v[68:71], v[24:27], v[44:47], v[68:71]
    s_waitcnt vmcnt(2)
    s_nop 0
    ds_read_b128 v[24:27], v16 offset:6144
    ds_read_b64_tr_b16 v[44:45], v17 offset:3072
    ds_read_b64_tr_b16 v[46:47], v17 offset:3136
    s_waitcnt lgkmcnt(12)
    s_nop 0
    v_mfma_f32_16x16x32_bf16 v[64:67], v[48:51], v[28:31], v[64:67]
    v_mfma_f32_16x16x32_bf16 v[68:71], v[28:31], v[48:51], v[68:71]
    s_waitcnt vmcnt(1)
    s_nop 0
    ds_read_b128 v[28:31], v16 offset:7168
    ds_read_b64_tr_b16 v[48:49], v17 offset:3584
    ds_read_b64_tr_b16 v[50:51], v17 offset:3648
    s_waitcnt lgkmcnt(12)
    s_nop 0
    v_mfma_f32_16x16x32_bf16 v[64:67], v[52:55], v[32:35], v[64:67]
    v_mfma_f32_16x16x32_bf16 v[68:71], v[32:35], v[52:55], v[68:71]
    s_waitcnt vmcnt(0)
    s_nop 0
    ds_read_b128 v[32:35], v16 offset:8192
    ds_read_b64_tr_b16 v[52:53], v17 offset:4096
    ds_read_b64_tr_b16 v[54:55], v17 offset:4160
    s_waitcnt lgkmcnt(12)
    s_nop 0
    v_mfma_f32_16x16x32_bf16 v[64:67], v[56:59], v[36:39], v[64:67]
    v_mfma_f32_16x16x32_bf16 v[68:71], v[36:39], v[56:59], v[68:71]
    ds_write_b32 v76, v73 offset:48
    buffer_load_dword v72, v75, s[56:59], 0 offen sc1
    s_mov_b32 s66, 160000
L_lw28:
    ds_read_b32 v60, v76 offset:240
    s_waitcnt lgkmcnt(0)
    v_cmp_gt_u32 vcc, 1, v60
    s_cbranch_vccz L_lw28_ok
    s_sub_u32 s66, s66, 1
    s_cmp_lg_u32 s66, 0
    s_cbranch_scc1 L_lw28
L_lw28_ok:
    ds_read_b128 v[36:39], v16 offset:9216
    ds_read_b64_tr_b16 v[56:57], v17 offset:4608
    ds_read_b64_tr_b16 v[58:59], v17 offset:4672
    s_waitcnt lgkmcnt(12)
    s_nop 0
    v_mfma_f32_16x16x32_bf16 v[64:67], v[40:43], v[20:23], v[64:67]
    v_mfma_f32_16x16x32_bf16 v[68:71], v[20:23], v[40:43], v[68:71]
    ds_read_b128 v[20:23], v16 offset:10240
    ds_read_b64_tr_b16 v[40:41], v17 offset:5120
    ds_read_b64_tr_b16 v[42:43], v17 offset:5184
    s_waitcnt lgkmcnt(12)
    s_nop 0
    v_mfma_f32_16x16x32_bf16 v[64:67], v[44:47], v[24:27], v[64:67]
    v_mfma_f32_16x16x32_bf16 v[68:71], v[24:27], v[44:47], v[68:71]
    ds_read_b128 v[24:27], v16 offset:11264
    ds_read_b64_tr_b16 v[44:45], v17 offset:5632
    ds_read_b64_tr_b16 v[46:47], v17 offset:5696
    s_waitcnt lgkmcnt(12)
    s_nop 0
    v_mfma_f32_16x16x32_bf16 v[64:67], v[48:51], v[28:31], v[64:67]
    v_mfma_f32_16x16x32_bf16 v[68:71], v[28:31], v[48:51], v[68:71]
    ds_read_b128 v[28:31], v16 offset:12288
    ds_read_b64_tr_b16 v[48:49], v17 offset:6144
    ds_read_b64_tr_b16 v[50:51], v17 offset:6208
    s_waitcnt lgkmcnt(12)
    s_nop 0
    v_mfma_f32_16x16x32_bf16 v[64:67], v[52:55], v[32:35], v[64:67]
    v_mfma_f32_16x16x32_bf16 v[68:71], v[32:35], v[52:55], v[68:71]
    ds_read_b128 v[32:35], v16 offset:13312
    ds_read_b64_tr_b16 v[52:53], v17 offset:6656
    ds_read_b64_tr_b16 v[54:55], v17 offset:6720
    s_waitcnt lgkmcnt(12)
    s_nop 0
    v_mfma_f32_16x16x32_bf16 v[64:67], v[56:59], v[36:39], v[64:67]
    v_mfma_f32_16x16x32_bf16 v[68:71], v[36:39], v[56:59], v[68:71]
    ds_read_b128 v[36:39], v16 offset:14336
    ds_read_b64_tr_b16 v[56:57], v17 offset:7168
    ds_read_b64_tr_b16 v[58:59], v17 offset:7232
    s_waitcnt lgkmcnt(12)
    s_nop 0
    v_mfma_f32_16x16x32_bf16 v[64:67], v[40:43], v[20:23], v[64:67]
    v_mfma_f32_16x16x32_bf16 v[68:71], v[20:23], v[40:43], v[68:71]
    ds_read_b128 v[20:23], v16 offset:15360
    ds_read_b64_tr_b16 v[40:41], v17 offset:7680
    ds_read_b64_tr_b16 v[42:43], v17 offset:7744
    s_waitcnt lgkmcnt(12)
    s_nop 0
    v_mfma_f32_16x16x32_bf16 v[64:67], v[44:47], v[24:27], v[64:67]
    v_mfma_f32_16x16x32_bf16 v[68:71], v[24:27], v[44:47], v[68:71]
    ds_read_b128 v[24:27], v16 offset:16384
    ds_read_b64_tr_b16 v[44:45], v17 offset:8192
    ds_read_b64_tr_b16 v[46:47], v17 offset:8256
    s_waitcnt lgkmcnt(12)
    s_nop 0
    v_mfma_f32_16x16x32_bf16 v[64:67], v[48:51], v[28:31], v[64:67]
    v_mfma_f32_16x16x32_bf16 v[68:71], v[28:31], v[48:51], v[68:71]
    ds_read_b128 v[28:31], v16 offset:17408
    ds_read_b64_tr_b16 v[48:49], v17 offset:8704
    ds_read_b64_tr_b16 v[50:51], v17 offset:8768
    s_waitcnt lgkmcnt(12)
    s_nop 0
    v_mfma_f32_16x16x32_bf16 v[64:67], v[52:55], v[32:35], v[64:67]
    v_mfma_f32_16x16x32_bf16 v[68:71], v[32:35], v[52:55], v[68:71]
    s_waitcnt lgkmcnt(9)
    s_nop 0
    v_mfma_f32_16x16x32_bf16 v[64:67], v[56:59], v[36:39], v[64:67]
    v_mfma_f32_16x16x32_bf16 v[68:71], v[36:39], v[56:59], v[68:71]
    s_waitcnt lgkmcnt(6)
    s_nop 0
    v_mfma_f32_16x16x32_bf16 v[64:67], v[40:43], v[20:23], v[64:67]
    v_mfma_f32_16x16x32_bf16 v[68:71], v[20:23], v[40:43], v[68:71]
    s_waitcnt lgkmcnt(3)
    s_nop 0
    v_mfma_f32_16x16x32_bf16 v[64:67], v[44:47], v[24:27], v[64:67]
    v_mfma_f32_16x16x32_bf16 v[68:71], v[24:27], v[44:47], v[68:71]
    s_waitcnt lgkmcnt(0)
    s_nop 0
    v_mfma_f32_16x16x32_bf16 v[64:67], v[48:51], v[28:31], v[64:67]
    v_mfma_f32_16x16x32_bf16 v[68:71], v[28:31], v[48:51], v[68:71]
    s_nop 6
    s_cmp_lt_u32 s5, 3
    s_cbranch_scc0 L_a_e3
    s_nop 0
    v_cvt_pk_bf16_f32 v20, v64, v65
    v_cvt_pk_bf16_f32 v21, v66, v67
    s_cmp_eq_u32 s5, 2
    s_cbranch_scc1 L_a_e2
    s_lshl_b32 s60, s5, 9
    v_lshlrev_b32 v18, 4, v6
    v_lshl_add_u32 v18, v15, 3, v18
    v_cmp_lt_u32 vcc, 31, v0
    s_add_u32 s64, s64, s60
    s_nop 0
    v_cndmask_b32 v18, v3, v18, vcc
    buffer_store_dwordx2 v[20:21], v18, s[40:43], s64 offen sc1
    s_branch L_a_edone
L_a_e2:
    v_cmp_lt_u32 vcc, 47, v0
    v_lshlrev_b32_e64 v18, 2, v6
    s_nop 0
    v_cndmask_b32 v18, v3, v18, vcc
    buffer_store_dword v21, v18, s[40:43], s64 offen offset:1024 sc1
    s_branch L_a_edone
L_a_e3:
    s_cmp_lt_u32 s5, 6
    s_cbranch_scc0 L_a_e6
    s_nop 0
    v_cvt_pk_bf16_f32 v20, v68, v69
    v_cvt_pk_bf16_f32 v21, v70, v71
    s_sub_u32 s60, s5, 3
    s_lshl_b32 s60, s60, 7
    s_cmp_eq_u32 s5, 5
    s_nop 0
    s_cselect_b32 s60, 160, s60
    s_cselect_b32 s61, 13, 7
    s_and_b32 s62, s6, 1
    s_mul_i32 s62, s62, 608
    s_add_u32 s64, s64, s62
    v_lshrrev_b32 v18, 5, v0
    v_mul_u32_u24 v18, 288, v18
    v_lshl_add_u32 v18, v4, 4, v18
    v_lshl_add_u32 v18, v15, 3, v18
    v_add_u32 v18, s60, v18
    v_cmp_lt_u32 vcc, s61, v4
    v_lshlrev_b32_e64 v22, 3, v5
    v_add_u32 v22, 704, v22
    v_cndmask_b32 v18, v3, v18, vcc
    s_cmp_eq_u32 s5, 5
    s_cbranch_scc0 L_a_e4
    v_cmp_gt_u32 vcc, 32, v0
    v_mov_b32 v23, 0x3f803f80
    s_nop 0
    v_cndmask_b32 v23, 0, v23, vcc
    v_cmp_eq_u32 vcc, 0, v4
    s_nop 1
    v_cndmask_b32 v18, v18, v22, vcc
    v_cndmask_b32 v20, v20, v23, vcc
    v_cndmask_b32 v21, v21, v23, vcc
L_a_e4:
    s_nop 0
    buffer_store_dwordx2 v[20:21], v18, s[40:43], s64 offen offset:1024 sc1
    s_branch L_a_edone
L_a_e6:
    s_nop 0
    v_mul_f32 v20, 3216550459, v64
    v_exp_f32 v20, v20
    s_lshl_b32 s60, s4, 8
    s_lshl_b32 s61, s6, 6
    v_add_f32 v20, 1.0, v20
    v_rcp_f32 v20, v20
    s_add_u32 s60, s60, s61
    s_add_u32 s60, s60, 2621440
    s_sub_u32 s61, s5, 4
    s_lshl_b32 s61, s61, 1
    s_sub_u32 s61, s61, 2
    v_cmp_eq_u32 vcc, s61, v5
    v_lshlrev_b32_e64 v18, 2, v4
    s_nop 0
    v_cndmask_b32 v18, v3, v18, vcc
    buffer_store_dword v20, v18, s[40:43], s60 offen sc1
L_a_edone:
    ds_write_b32 v76, v73 offset:64
    s_mov_b32 s66, 20000
L_a_clrw:
    s_waitcnt vmcnt(0)
    v_cmp_ne_u32 vcc, 1, v72
    s_cbranch_vccz L_a_clrok
    s_sub_u32 s66, s66, 1
    s_cmp_eq_u32 s66, 0
    s_cbranch_scc1 L_a_clrok
    s_sleep 2
    s_nop 0
    buffer_load_dword v72, v75, s[56:59], 0 offen sc1
    s_branch L_a_clrw
L_a_clrok:
    s_nop 0
    ds_write_b32 v76, v73 offset:80
    s_lshl_b32 s60, s4, 7
    s_lshl_b32 s61, s5, 2
    s_add_u32 s60, s60, s61
    s_nop 0
    s_add_u32 s60, s60, 196608
    s_lshr_b32 s65, s4, 3
    s_add_u32 s65, s65, s61
    s_lshl_b32 s65, s65, 7
    s_and_b32 s61, s4, 7
    s_lshl_b32 s61, s61, 2
    s_add_u32 s65, s65, s61
    s_add_u32 s65, s65, 200704
    v_cmp_eq_u32 vcc, 0, v0
    v_mov_b32 v17, 0
    s_cmp_eq_u32 s6, 0
    v_cndmask_b32 v17, v3, v17, vcc
    s_cbranch_scc0 L_a_nsig
    s_nop 0
    s_mov_b32 s66, 160000
L_lw29:
    ds_read_b128 v[20:23], v2 offset:80
    s_waitcnt lgkmcnt(0)
    v_min_u32 v20, v20, v21
    v_min3_u32 v20, v20, v22, v23
    v_cmp_gt_u32 vcc, 1, v20
    s_cbranch_vccz L_lw29_ok
    s_sleep 1
    s_sub_u32 s66, s66, 1
    s_cmp_lg_u32 s66, 0
    s_cbranch_scc1 L_lw29
L_lw29_ok:
    s_getreg_b32 s61, hwreg(HW_REG_XCC_ID, 0, 4)
    s_add_u32 s61, s61, 1
    v_mov_b32_e64 v20, s61
    buffer_store_dword v20, v17, s[40:43], s60 offen sc1
    s_sleep 16
    s_nop 0
    ds_write_b32 v2, v73 offset:496
L_a_nsig:
    s_waitcnt lgkmcnt(0)
    v_and_b32 v24, 15, v0
    v_bfe_u32 v25, v0, 4, 1
    v_lshrrev_b32 v23, 5, v0
    v_and_b32 v9, 7, v0
    v_bfe_u32 v21, v0, 3, 1
    v_lshl_or_b32 v9, v9, 1, v21
    v_lshlrev_b32 v11, 3, v25
    v_lshlrev_b32 v20, 4, v23
    v_sub_u32 v11, v11, v20
    v_sub_u32 v11, v11, v9
    v_add_u32 v11, 2047, v11
    v_lshlrev_b32 v11, 1, v11
    v_xor_b32 v20, 1, v21
    v_mul_u32_u24 v20, 4222, v20
    v_add_u32 v26, v11, v20
    v_sub_u32 v11, v24, v23
    v_lshlrev_b32_e64 v11, 5, v11
    v_lshl_add_u32 v27, v25, 4, v11
    s_and_b32 s70, s6, 1
    s_lshl_b32 s60, s70, 8
    s_add_u32 s61, s60, 3776
    v_subrev_u32 v4, s61, v26
    v_subrev_u32 v28, s60, v27
    v_subrev_u32_e64 v29, 64, v28
    v_subrev_u32 v30, 128, v28
    v_subrev_u32 v31, 192, v28
    v_add_u32 v5, 320, v28
    v_lshlrev_b32 v11, 5, v24
    v_lshlrev_b32 v20, 4, v25
    v_sub_u32_e64 v11, v20, v11
    v_add_u32 v7, 480, v11
    v_lshl_or_b32 v11, v25, 1, v23
    v_lshlrev_b32_e64 v11, 3, v11
    v_lshl_add_u32 v8, v24, 5, v11
    s_lshl_b32 s60, s6, 11
    s_nop 0
    s_add_u32 s60, s60, 151552
    v_add_u32 v6, s60, v1
    s_xor_b32 s60, s39, 4
    v_add_u32_e64 v10, s60, v2
    s_mul_i32 s64, s5, 72
    s_add_u32 s64, s64, s4
    s_lshr_b32 s60, s6, 1
    s_lshl_b32 s60, s60, 5
    s_add_u32 s64, s64, s60
    s_lshl_b32 s67, s64, 12
    s_nop 0
    s_add_u32 s67, s67, 9961472
    v_lshlrev_b32 v11, 3, v25
    v_add_u32 v11, v11, v9
    v_sub_u32_e64 v11, 15, v11
    v_lshl_add_u32 v11, v23, 4, v11
    v_and_b32 v20, 1, v11
    v_lshlrev_b32 v20, 4, v20
    v_lshrrev_b32 v11, 1, v11
    s_lshl_b32 s60, s70, 4
    v_add_u32 v11, s60, v11
    v_mov_b32 v154, v4
    v_mov_b32 v155, v5
    v_mov_b32 v156, v28
    v_mov_b32 v157, v7
    v_mov_b32 v158, v8
    v_mov_b32 v159, v6
    v_mov_b32 v160, v10
    v_mov_b32 v161, v26
    v_mov_b32 v162, v27
    v_mov_b32_e64 v163, v11
    v_mov_b32 v164, v20
    s_barrier
    s_barrier
    s_lshl_b32 s60, s6, 10
    s_add_u32 s60, s60, 14336
    s_add_u32 s61, s60, 75776
    v_mov_b32_e64 v18, 1
    s_mov_b32 m0, s60
    s_nop 0
    buffer_load_dwordx4 v1, s[40:43], s60 offen lds
    s_mov_b32 m0, s61
    s_nop 0
    s_add_u32 s60, s60, 4096
    buffer_load_dwordx4 v1, s[40:43], s61 offen lds
    s_add_u32 s61, s61, 4096
    s_mov_b32 m0, s60
    s_nop 0
    buffer_load_dwordx4 v1, s[40:43], s60 offen lds
    s_mov_b32 m0, s61
    s_nop 0
    s_add_u32 s60, s60, 4096
    buffer_load_dwordx4 v1, s[40:43], s61 offen lds
    s_add_u32 s61, s61, 4096
    s_barrier
    s_mov_b32 m0, s60
    s_nop 0
    s_nop 0
    buffer_load_dwordx4 v1, s[40:43], s60 offen lds
    s_mov_b32 m0, s61
    s_nop 0
    s_add_u32 s60, s60, 4096
    buffer_load_dwordx4 v1, s[40:43], s61 offen lds
    s_add_u32 s61, s61, 4096
    s_mov_b32 m0, s60
    s_nop 0
    buffer_load_dwordx4 v1, s[40:43], s60 offen lds
    s_mov_b32 m0, s61
    s_nop 0
    s_add_u32 s60, s60, 4096
    buffer_load_dwordx4 v1, s[40:43], s61 offen lds
    s_add_u32 s61, s61, 4096
    s_mov_b32 m0, s60
    s_nop 0
    buffer_load_dwordx4 v1, s[40:43], s60 offen lds
    s_mov_b32 m0, s61
    s_nop 0
    s_add_u32 s60, s60, 4096
    buffer_load_dwordx4 v1, s[40:43], s61 offen lds
    s_add_u32 s61, s61, 4096
    s_mov_b32 m0, s60
    s_nop 0
    buffer_load_dwordx4 v1, s[40:43], s60 offen lds
    s_mov_b32 m0, s61
    s_nop 0
    s_add_u32 s60, s60, 4096
    buffer_load_dwordx4 v1, s[40:43], s61 offen lds
    s_add_u32 s61, s61, 4096
    s_mov_b32 m0, s60
    s_nop 0
    buffer_load_dwordx4 v1, s[40:43], s60 offen lds
    s_mov_b32 m0, s61
    s_nop 0
    s_add_u32 s60, s60, 4096
    buffer_load_dwordx4 v1, s[40:43], s61 offen lds
    s_add_u32 s61, s61, 4096
    s_mov_b32 m0, s60
    s_nop 0
    buffer_load_dwordx4 v1, s[40:43], s60 offen lds
    s_mov_b32 m0, s61
    s_nop 0
    s_add_u32 s60, s60, 4096
    buffer_load_dwordx4 v1, s[40:43], s61 offen lds
    s_add_u32 s61, s61, 4096
    s_mov_b32 s44, s20
    s_nop 0
    s_and_b32 s45, s21, 0xffff
    s_mov_b32 s46, 2359296
    s_mov_b32 s47, 0x00020000
    s_mov_b32 s48, s22
    s_nop 0
    s_and_b32 s49, s23, 0xffff
    s_mov_b32 s50, 2359296
    s_mov_b32 s51, 0x00020000
    s_mov_b32 s52, s24
    s_nop 0
    s_and_b32 s53, s25, 0xffff
    s_mov_b32 s54, 4608
    s_mov_b32 s55, 0x00020000
    s_mul_i32 s62, s6, 18432
    s_add_u32 s62, s62, s18
    s_add_u32 s62, s62, s19
    v_lshlrev_b32_e64 v4, 2, v0
    v_add_u32 v4, s62, v4
    v_cmp_gt_u32 vcc, 36, v0
    s_mul_i32 s63, s5, 576
    v_add_u32_e64 v6, s63, v1
    v_cndmask_b32 v4, v3, v4, vcc
    v_cndmask_b32 v6, v3, v6, vcc
    v_subrev_u32 v5, 4608, v4
    buffer_load_dwordx4 v[60:63], v6, s[52:55], 0 offen
    s_mov_b32 s62, 0
    s_nop 0
    buffer_load_dword v20, v5, s[44:47], 0 offen offset:0
    buffer_load_dword v21, v5, s[44:47], 0 offen offset:1152
    buffer_load_dword v22, v5, s[44:47], 0 offen offset:2304
    buffer_load_dword v23, v5, s[44:47], 0 offen offset:3456
    buffer_load_dword v40, v5, s[48:51], 0 offen offset:3456
    s_waitcnt vmcnt(6)
    s_nop 0
    ds_write_b32 v19, v18 offset:128
    buffer_load_dword v24, v4, s[44:47], s62 offen offset:0
    buffer_load_dword v41, v4, s[48:51], s62 offen offset:0
    buffer_load_dword v25, v4, s[44:47], s62 offen offset:1152
    buffer_load_dword v42, v4, s[48:51], s62 offen offset:1152
    buffer_load_dword v26, v4, s[44:47], s62 offen offset:2304
    buffer_load_dword v43, v4, s[48:51], s62 offen offset:2304
    buffer_load_dword v27, v4, s[44:47], s62 offen offset:3456
    buffer_load_dword v44, v4, s[48:51], s62 offen offset:3456
    s_add_u32 s62, s62, 4608
    buffer_load_dword v28, v4, s[44:47], s62 offen offset:0
    buffer_load_dword v45, v4, s[48:51], s62 offen offset:0
    buffer_load_dword v29, v4, s[44:47], s62 offen offset:1152
    buffer_load_dword v46, v4, s[48:51], s62 offen offset:1152
    buffer_load_dword v30, v4, s[44:47], s62 offen offset:2304
    buffer_load_dword v47, v4, s[48:51], s62 offen offset:2304
    buffer_load_dword v31, v4, s[44:47], s62 offen offset:3456
    buffer_load_dword v48, v4, s[48:51], s62 offen offset:3456
    s_add_u32 s62, s62, 4608
    buffer_load_dword v32, v4, s[44:47], s62 offen offset:0
    buffer_load_dword v49, v4, s[48:51], s62 offen offset:0
    buffer_load_dword v33, v4, s[44:47], s62 offen offset:1152
    buffer_load_dword v50, v4, s[48:51], s62 offen offset:1152
    buffer_load_dword v34, v4, s[44:47], s62 offen offset:2304
    buffer_load_dword v51, v4, s[48:51], s62 offen offset:2304
    buffer_load_dword v35, v4, s[44:47], s62 offen offset:3456
    buffer_load_dword v52, v4, s[48:51], s62 offen offset:3456
    s_add_u32 s62, s62, 4608
    buffer_load_dword v36, v4, s[44:47], s62 offen offset:0
    buffer_load_dword v53, v4, s[48:51], s62 offen offset:0
    buffer_load_dword v37, v4, s[44:47], s62 offen offset:1152
    buffer_load_dword v54, v4, s[48:51], s62 offen offset:1152
    buffer_load_dword v38, v4, s[44:47], s62 offen offset:2304
    buffer_load_dword v55, v4, s[48:51], s62 offen offset:2304
    buffer_load_dword v39, v4, s[44:47], s62 offen offset:3456
    buffer_load_dword v56, v4, s[48:51], s62 offen offset:3456
    s_add_u32 s62, s62, 4608
    s_mov_b32 m0, s60
    s_nop 0
    buffer_load_dwordx4 v1, s[40:43], s60 offen lds
    s_mov_b32 m0, s61
    s_nop 0
    s_add_u32 s60, s60, 4096
    buffer_load_dwordx4 v1, s[40:43], s61 offen lds
    s_add_u32 s61, s61, 4096
    s_mov_b32 m0, s60
    s_nop 0
    buffer_load_dwordx4 v1, s[40:43], s60 offen lds
    s_mov_b32 m0, s61
    s_nop 0
    s_add_u32 s60, s60, 4096
    buffer_load_dwordx4 v1, s[40:43], s61 offen lds
    s_add_u32 s61, s61, 4096
    s_mov_b32 m0, s60
    s_nop 0
    buffer_load_dwordx4 v1, s[40:43], s60 offen lds
    s_mov_b32 m0, s61
    s_nop 0
    s_add_u32 s60, s60, 4096
    buffer_load_dwordx4 v1, s[40:43], s61 offen lds
    s_add_u32 s61, s61, 4096
    s_mov_b32 m0, s60
    s_nop 0
    buffer_load_dwordx4 v1, s[40:43], s60 offen lds
    s_mov_b32 m0, s61
    s_nop 0
    s_add_u32 s60, s60, 4096
    buffer_load_dwordx4 v1, s[40:43], s61 offen lds
    s_add_u32 s61, s61, 4096
    s_mov_b32 m0, s60
    s_nop 0
    buffer_load_dwordx4 v1, s[40:43], s60 offen lds
    s_mov_b32 m0, s61
    s_nop 0
    s_add_u32 s60, s60, 4096
    buffer_load_dwordx4 v1, s[40:43], s61 offen lds
    s_add_u32 s61, s61, 4096
    s_mov_b32 m0, s60
    s_nop 0
    buffer_load_dwordx4 v1, s[40:43], s60 offen lds
    s_mov_b32 m0, s61
    s_nop 0
    s_add_u32 s60, s60, 4096
    buffer_load_dwordx4 v1, s[40:43], s61 offen lds
    s_add_u32 s61, s61, 4096
    s_mov_b32 m0, s60
    s_nop 0
    buffer_load_dwordx4 v1, s[40:43], s60 offen lds
    s_mov_b32 m0, s61
    s_nop 0
    s_add_u32 s60, s60, 4096
    buffer_load_dwordx4 v1, s[40:43], s61 offen lds
    s_add_u32 s61, s61, 4096
    s_lshl_b32 s60, s6, 5
    s_nop 0
    s_sub_u32 s60, 151648, s60
    v_mul_u32_u24 v4, 288, v0
    v_add_u32 v4, s60, v4
    s_waitcnt vmcnt(8)
    ds_write_b32 v19, v18 offset:144
    v_lshlrev_b32_e64 v64, 16, v20
    v_and_b32 v65, 0xffff0000, v20
    v_lshlrev_b32_e64 v66, 16, v21
    v_and_b32 v67, 0xffff0000, v21
    v_lshlrev_b32_e64 v68, 16, v22
    v_and_b32 v69, 0xffff0000, v22
    v_lshlrev_b32_e64 v70, 16, v23
    v_and_b32 v71, 0xffff0000, v23
    v_lshlrev_b32_e64 v72, 16, v24
    v_and_b32 v73, 0xffff0000, v24
    v_lshlrev_b32_e64 v74, 16, v25
    v_and_b32 v75, 0xffff0000, v25
    v_lshlrev_b32_e64 v76, 16, v26
    v_and_b32 v77, 0xffff0000, v26
    v_lshlrev_b32_e64 v78, 16, v27
    v_and_b32 v79, 0xffff0000, v27
    v_lshlrev_b32_e64 v80, 16, v28
    v_and_b32 v81, 0xffff0000, v28
    v_lshlrev_b32_e64 v82, 16, v29
    v_and_b32 v83, 0xffff0000, v29
    v_lshlrev_b32_e64 v84, 16, v30
    v_and_b32 v85, 0xffff0000, v30
    v_lshlrev_b32_e64 v86, 16, v31
    v_and_b32 v87, 0xffff0000, v31
    v_lshlrev_b32_e64 v88, 16, v32
    v_and_b32 v89, 0xffff0000, v32
    v_lshlrev_b32_e64 v90, 16, v33
    v_and_b32 v91, 0xffff0000, v33
    v_lshlrev_b32_e64 v92, 16, v34
    v_and_b32 v93, 0xffff0000, v34
    v_lshlrev_b32_e64 v94, 16, v35
    v_and_b32 v95, 0xffff0000, v35
    v_lshlrev_b32_e64 v96, 16, v36
    v_and_b32 v97, 0xffff0000, v36
    v_lshlrev_b32_e64 v98, 16, v37
    v_and_b32 v99, 0xffff0000, v37
    v_lshlrev_b32_e64 v100, 16, v38
    v_and_b32 v101, 0xffff0000, v38
    v_lshlrev_b32_e64 v102, 16, v39
    v_and_b32 v103, 0xffff0000, v39
    v_lshlrev_b32_e64 v104, 16, v40
    v_and_b32 v105, 0xffff0000, v40
    v_lshlrev_b32_e64 v106, 16, v41
    v_and_b32 v107, 0xffff0000, v41
    v_lshlrev_b32_e64 v108, 16, v42
    v_and_b32 v109, 0xffff0000, v42
    v_lshlrev_b32_e64 v110, 16, v43
    v_and_b32 v111, 0xffff0000, v43
    v_lshlrev_b32_e64 v112, 16, v44
    v_and_b32 v113, 0xffff0000, v44
    v_lshlrev_b32_e64 v114, 16, v45
    v_and_b32 v115, 0xffff0000, v45
    v_lshlrev_b32_e64 v116, 16, v46
    v_and_b32 v117, 0xffff0000, v46
    v_lshlrev_b32_e64 v118, 16, v47
    v_and_b32 v119, 0xffff0000, v47
    v_lshlrev_b32_e64 v120, 16, v48
    v_and_b32 v121, 0xffff0000, v48
    v_lshlrev_b32_e64 v122, 16, v49
    v_and_b32 v123, 0xffff0000, v49
    v_lshlrev_b32_e64 v124, 16, v50
    v_and_b32 v125, 0xffff0000, v50
    v_lshlrev_b32_e64 v126, 16, v51
    v_and_b32 v127, 0xffff0000, v51
    v_lshlrev_b32_e64 v128, 16, v52
    v_and_b32 v129, 0xffff0000, v52
    v_lshlrev_b32_e64 v130, 16, v53
    v_and_b32 v131, 0xffff0000, v53
    v_lshlrev_b32_e64 v132, 16, v54
    v_and_b32 v133, 0xffff0000, v54
    v_lshlrev_b32_e64 v134, 16, v55
    v_and_b32 v135, 0xffff0000, v55
    v_lshlrev_b32_e64 v136, 16, v56
    v_and_b32 v137, 0xffff0000, v56
    v_lshlrev_b32 v138, 16, v60
    v_lshlrev_b32 v139, 16, v62
    v_and_b32 v140, 0xffff0000, v60
    v_and_b32 v141, 0xffff0000, v62
    v_lshlrev_b32 v142, 16, v61
    v_lshlrev_b32 v143, 16, v63
    v_and_b32 v144, 0xffff0000, v61
    v_and_b32 v145, 0xffff0000, v63
    v_pk_mul_f32 v[146:147], v[138:139], v[70:71]
    v_pk_fma_f32 v[146:147], v[140:141], v[68:69], v[146:147]
    v_pk_fma_f32 v[146:147], v[142:143], v[66:67], v[146:147]
    v_pk_fma_f32 v[146:147], v[144:145], v[64:65], v[146:147]
    v_pk_mul_f32 v[104:105], v[146:147], v[104:105]
    v_pk_mul_f32 v[148:149], v[138:139], v[72:73]
    v_pk_fma_f32 v[148:149], v[140:141], v[70:71], v[148:149]
    v_pk_fma_f32 v[148:149], v[142:143], v[68:69], v[148:149]
    v_pk_fma_f32 v[148:149], v[144:145], v[66:67], v[148:149]
    v_pk_mul_f32 v[106:107], v[148:149], v[106:107]
    v_pk_mul_f32 v[150:151], v[138:139], v[74:75]
    v_pk_fma_f32 v[150:151], v[140:141], v[72:73], v[150:151]
    v_pk_fma_f32 v[150:151], v[142:143], v[70:71], v[150:151]
    v_pk_fma_f32 v[150:151], v[144:145], v[68:69], v[150:151]
    v_pk_mul_f32 v[108:109], v[150:151], v[108:109]
    v_pk_mul_f32 v[152:153], v[138:139], v[76:77]
    v_pk_fma_f32 v[152:153], v[140:141], v[74:75], v[152:153]
    v_pk_fma_f32 v[152:153], v[142:143], v[72:73], v[152:153]
    v_pk_fma_f32 v[152:153], v[144:145], v[70:71], v[152:153]
    v_pk_mul_f32 v[110:111], v[152:153], v[110:111]
    v_pk_mul_f32 v[146:147], v[138:139], v[78:79]
    v_pk_fma_f32 v[146:147], v[140:141], v[76:77], v[146:147]
    v_pk_fma_f32 v[146:147], v[142:143], v[74:75], v[146:147]
    v_pk_fma_f32 v[146:147], v[144:145], v[72:73], v[146:147]
    v_pk_mul_f32 v[112:113], v[146:147], v[112:113]
    v_pk_mul_f32 v[148:149], v[138:139], v[80:81]
    v_pk_fma_f32 v[148:149], v[140:141], v[78:79], v[148:149]
    v_pk_fma_f32 v[148:149], v[142:143], v[76:77], v[148:149]
    v_pk_fma_f32 v[148:149], v[144:145], v[74:75], v[148:149]
    v_pk_mul_f32 v[114:115], v[148:149], v[114:115]
    v_pk_mul_f32 v[150:151], v[138:139], v[82:83]
    v_pk_fma_f32 v[150:151], v[140:141], v[80:81], v[150:151]
    v_pk_fma_f32 v[150:151], v[142:143], v[78:79], v[150:151]
    v_pk_fma_f32 v[150:151], v[144:145], v[76:77], v[150:151]
    v_pk_mul_f32 v[116:117], v[150:151], v[116:117]
    v_pk_mul_f32 v[152:153], v[138:139], v[84:85]
    v_pk_fma_f32 v[152:153], v[140:141], v[82:83], v[152:153]
    v_pk_fma_f32 v[152:153], v[142:143], v[80:81], v[152:153]
    v_pk_fma_f32 v[152:153], v[144:145], v[78:79], v[152:153]
    v_pk_mul_f32 v[118:119], v[152:153], v[118:119]
    v_pk_mul_f32 v[146:147], v[138:139], v[86:87]
    v_pk_fma_f32 v[146:147], v[140:141], v[84:85], v[146:147]
    v_pk_fma_f32 v[146:147], v[142:143], v[82:83], v[146:147]
    v_pk_fma_f32 v[146:147], v[144:145], v[80:81], v[146:147]
    v_pk_mul_f32 v[120:121], v[146:147], v[120:121]
    v_pk_mul_f32 v[148:149], v[138:139], v[88:89]
    v_pk_fma_f32 v[148:149], v[140:141], v[86:87], v[148:149]
    v_pk_fma_f32 v[148:149], v[142:143], v[84:85], v[148:149]
    v_pk_fma_f32 v[148:149], v[144:145], v[82:83], v[148:149]
    v_pk_mul_f32 v[122:123], v[148:149], v[122:123]
    v_pk_mul_f32 v[150:151], v[138:139], v[90:91]
    v_pk_fma_f32 v[150:151], v[140:141], v[88:89], v[150:151]
    v_pk_fma_f32 v[150:151], v[142:143], v[86:87], v[150:151]
    v_pk_fma_f32 v[150:151], v[144:145], v[84:85], v[150:151]
    v_pk_mul_f32 v[124:125], v[150:151], v[124:125]
    v_pk_mul_f32 v[152:153], v[138:139], v[92:93]
    v_pk_fma_f32 v[152:153], v[140:141], v[90:91], v[152:153]
    v_pk_fma_f32 v[152:153], v[142:143], v[88:89], v[152:153]
    v_pk_fma_f32 v[152:153], v[144:145], v[86:87], v[152:153]
    v_pk_mul_f32 v[126:127], v[152:153], v[126:127]
    v_pk_mul_f32 v[146:147], v[138:139], v[94:95]
    v_pk_fma_f32 v[146:147], v[140:141], v[92:93], v[146:147]
    v_pk_fma_f32 v[146:147], v[142:143], v[90:91], v[146:147]
    v_pk_fma_f32 v[146:147], v[144:145], v[88:89], v[146:147]
    v_pk_mul_f32 v[128:129], v[146:147], v[128:129]
    v_pk_mul_f32 v[148:149], v[138:139], v[96:97]
    v_pk_fma_f32 v[148:149], v[140:141], v[94:95], v[148:149]
    v_pk_fma_f32 v[148:149], v[142:143], v[92:93], v[148:149]
    v_pk_fma_f32 v[148:149], v[144:145], v[90:91], v[148:149]
    v_pk_mul_f32 v[130:131], v[148:149], v[130:131]
    v_pk_mul_f32 v[150:151], v[138:139], v[98:99]
    v_pk_fma_f32 v[150:151], v[140:141], v[96:97], v[150:151]
    v_pk_fma_f32 v[150:151], v[142:143], v[94:95], v[150:151]
    v_pk_fma_f32 v[150:151], v[144:145], v[92:93], v[150:151]
    v_pk_mul_f32 v[132:133], v[150:151], v[132:133]
    v_pk_mul_f32 v[152:153], v[138:139], v[100:101]
    v_pk_fma_f32 v[152:153], v[140:141], v[98:99], v[152:153]
    v_pk_fma_f32 v[152:153], v[142:143], v[96:97], v[152:153]
    v_pk_fma_f32 v[152:153], v[144:145], v[94:95], v[152:153]
    v_pk_mul_f32 v[134:135], v[152:153], v[134:135]
    v_pk_mul_f32 v[146:147], v[138:139], v[102:103]
    v_pk_fma_f32 v[146:147], v[140:141], v[100:101], v[146:147]
    v_pk_fma_f32 v[146:147], v[142:143], v[98:99], v[146:147]
    v_pk_fma_f32 v[146:147], v[144:145], v[96:97], v[146:147]
    v_pk_mul_f32 v[136:137], v[146:147], v[136:137]
    v_cvt_pk_bf16_f32 v20, v136, v134
    v_cvt_pk_bf16_f32 v21, v132, v130
    v_cvt_pk_bf16_f32 v22, v128, v126
    v_cvt_pk_bf16_f32 v23, v124, v122
    v_cvt_pk_bf16_f32 v24, v120, v118
    v_cvt_pk_bf16_f32 v25, v116, v114
    v_cvt_pk_bf16_f32 v26, v112, v110
    v_cvt_pk_bf16_f32 v27, v108, v106
    v_cvt_pk_bf16_f32 v28, v137, v135
    v_cvt_pk_bf16_f32 v29, v133, v131
    v_cvt_pk_bf16_f32 v30, v129, v127
    v_cvt_pk_bf16_f32 v31, v125, v123
    v_cvt_pk_bf16_f32 v32, v121, v119
    v_cvt_pk_bf16_f32 v33, v117, v115
    v_cvt_pk_bf16_f32 v34, v113, v111
    v_cvt_pk_bf16_f32 v35, v109, v107
    v_cvt_pk_bf16_f32 v36, v104, v105
    s_setprio 3
    v_cmp_gt_u32 vcc, 36, v0
    s_and_saveexec_b64 s[62:63], vcc
    s_nop 0
    ds_write_b128 v4, v[20:23]
    ds_write_b128 v4, v[24:27] offset:16
    ds_write_b128 v4, v[28:31] offset:144
    ds_write_b128 v4, v[32:35] offset:160
    s_cmp_eq_u32 s6, 0
    s_cbranch_scc0 L_a_nx64
    ds_write_b16 v4, v36 offset:32
    ds_write_b16_d16_hi v4, v36 offset:176
L_a_nx64:
    s_mov_b64 exec, s[62:63]
    s_waitcnt vmcnt(0) lgkmcnt(0)
    ds_write_b32 v19, v18 offset:96
    ds_write_b32 v19, v18 offset:160
    s_mul_i32 s60, s5, 72
    s_mul_i32 s61, s6, 18
    s_add_u32 s60, s60, s61
    s_mul_i32 s60, s60, 8448
    s_lshl_b32 s62, s4, 7
    s_sub_u32 s60, s60, s62
    s_add_u32 s60, s60, 2690944
    s_add_u32 s62, s60, 4224
    s_mul_i32 s61, s61, 144
    s_add_u32 s61, s61, 151552
    v_lshrrev_b32 v5, 3, v0
    v_and_b32 v6, 7, v0
    v_lshlrev_b32_e64 v6, 4, v6
    v_mul_u32_u24 v7, 144, v5
    v_add3_u32 v7, v7, v6, s61
    v_mul_u32_u24 v8, 8448, v5
    v_add_u32_e64 v8, v8, v6
    v_add_u32 v9, 67584, v8
    v_add_u32 v10, 135168, v8
    v_cmp_gt_u32 vcc, 16, v0
    s_nop 1
    v_cndmask_b32 v10, v3, v10, vcc
    s_nop 0
    s_mov_b32 s66, 160000
L_lw30:
    ds_read_b128 v[40:43], v2 offset:96
    s_waitcnt lgkmcnt(0)
    v_min_u32 v40, v40, v41
    v_min3_u32 v40, v40, v42, v43
    v_cmp_gt_u32 vcc, 1, v40
    s_cbranch_vccz L_lw30_ok
    s_sleep 2
    s_sub_u32 s66, s66, 1
    s_cmp_lg_u32 s66, 0
    s_cbranch_scc1 L_lw30
L_lw30_ok:
    ds_read_b128 v[40:43], v7 offset:0
    ds_read_b32 v68, v7 offset:16
    ds_read_b128 v[48:51], v7 offset:1152
    ds_read_b32 v69, v7 offset:1168
    ds_read_b128 v[56:59], v7 offset:2304
    ds_read_b32 v70, v7 offset:2320
    s_waitcnt lgkmcnt(4)
    s_nop 0
    buffer_store_dwordx4 v[40:43], v8, s[40:43], s60 offen sc1
    v_alignbit_b32 v44, v41, v40, 16
    v_alignbit_b32 v45, v42, v41, 16
    v_alignbit_b32 v46, v43, v42, 16
    v_alignbit_b32 v47, v68, v43, 16
    buffer_store_dwordx4 v[44:47], v8, s[40:43], s62 offen sc1
    s_waitcnt lgkmcnt(2)
    s_nop 0
    buffer_store_dwordx4 v[48:51], v9, s[40:43], s60 offen sc1
    v_alignbit_b32 v52, v49, v48, 16
    v_alignbit_b32 v53, v50, v49, 16
    v_alignbit_b32 v54, v51, v50, 16
    v_alignbit_b32 v55, v69, v51, 16
    buffer_store_dwordx4 v[52:55], v9, s[40:43], s62 offen sc1
    s_waitcnt lgkmcnt(0)
    s_nop 0
    buffer_store_dwordx4 v[56:59], v10, s[40:43], s60 offen sc1
    v_alignbit_b32 v60, v57, v56, 16
    v_alignbit_b32 v61, v58, v57, 16
    v_alignbit_b32 v62, v59, v58, 16
    v_alignbit_b32 v63, v70, v59, 16
    buffer_store_dwordx4 v[60:63], v10, s[40:43], s62 offen sc1
    ds_write_b32 v19, v18 offset:112
    v_mov_b32 v64, 0
    v_mov_b32 v65, 0
    v_mov_b32 v66, 0
    v_mov_b32 v67, 0
    s_cmp_eq_u32 s4, 0
    s_cbranch_scc0 L_a_nopad
    buffer_store_dwordx4 v[64:67], v8, s[40:43], s60 offen offset:128 sc1
    buffer_store_dwordx4 v[64:67], v8, s[40:43], s62 offen offset:128 sc1
    buffer_store_dwordx4 v[64:67], v9, s[40:43], s60 offen offset:128 sc1
    buffer_store_dwordx4 v[64:67], v9, s[40:43], s62 offen offset:128 sc1
    buffer_store_dwordx4 v[64:67], v10, s[40:43], s60 offen offset:128 sc1
    buffer_store_dwordx4 v[64:67], v10, s[40:43], s62 offen offset:128 sc1
L_a_nopad:
    v_mov_b32 v4, v154
    v_mov_b32 v5, v155
    v_mov_b32 v28, v156
    v_mov_b32 v7, v157
    v_mov_b32 v8, v158
    v_mov_b32 v6, v159
    v_mov_b32 v10, v160
    v_mov_b32 v26, v161
    v_mov_b32 v27, v162
    v_mov_b32 v11, v163
    v_mov_b32 v20, v164
    v_subrev_u32 v29, 64, v28
    v_subrev_u32 v30, 128, v28
    v_subrev_u32 v31, 192, v28
    s_lshl_b32 s60, s64, 12
    s_add_u32 s44, s26, s60
    s_addc_u32 s45, s27, 0
    s_nop 0
    s_and_b32 s45, s45, 0xffff
    s_mov_b32 s46, 4096
    s_mov_b32 s47, 0x00020000
    s_mul_i32 s60, s64, 8448
    s_add_u32 s60, s60, 2686976
    s_add_u32 s48, s36, s60
    s_addc_u32 s49, s37, 0
    s_and_b32 s49, s49, 0xffff
    s_mov_b32 s50, 8448
    s_mov_b32 s51, 0x00020000
    s_lshl_b32 s60, s64, 1
    v_mov_b32 v21, s60
    s_mov_b32 s52, s28
    s_nop 0
    s_and_b32 s53, s29, 0xffff
    s_mov_b32 s54, 1152
    s_mov_b32 s55, 0x00020000
    s_waitcnt vmcnt(0)
    s_nop 0
    ds_write_b32 v19, v18 offset:208
    buffer_load_ushort v22, v21, s[52:55], 0 offen
    buffer_load_dwordx4 v[64:67], v28, s[44:47], 0 offen
    buffer_load_dwordx4 v[68:71], v5, s[44:47], 0 offen offset:192
    buffer_load_dwordx4 v[72:75], v5, s[44:47], 0 offen offset:704
    buffer_load_dwordx4 v[76:79], v5, s[44:47], 0 offen offset:1216
    buffer_load_dwordx4 v[80:83], v5, s[44:47], 0 offen offset:1728
    buffer_load_dwordx4 v[84:87], v5, s[44:47], 0 offen offset:2240
    buffer_load_dwordx4 v[88:91], v5, s[44:47], 0 offen offset:2752
    buffer_load_dwordx4 v[92:95], v5, s[44:47], 0 offen offset:3264
    s_cmp_eq_u32 s6, 3
    s_cbranch_scc0 L_a_uw
    s_mov_b32 s66, 160000
L_lw31:
    ds_read_b128 v[40:43], v2 offset:208
    s_waitcnt lgkmcnt(0)
    v_min_u32 v40, v40, v41
    v_min3_u32 v40, v40, v42, v43
    v_cmp_gt_u32 vcc, 1, v40
    s_cbranch_vccz L_lw31_ok
    s_sleep 3
    s_sub_u32 s66, s66, 1
    s_cmp_lg_u32 s66, 0
    s_cbranch_scc1 L_lw31
L_lw31_ok:
    buffer_store_dword v18, v17, s[40:43], s65 offen sc1
    v_bfe_u32 v16, v0, 1, 2
    v_lshlrev_b32 v16, 7, v16
    v_and_b32 v21, 1, v0
    v_lshl_add_u32 v16, v21, 4, v16
    s_lshl_b32 s69, s5, 9
    s_nop 0
    s_add_u32 s69, s69, 200704
    s_mov_b32 s66, 20000
    s_sleep 24
L_a_upoll:
    s_nop 0
    buffer_load_dwordx4 v[40:43], v16, s[40:43], s69 offen sc1
    s_waitcnt vmcnt(0)
    v_and_b32 v40, v40, v41
    v_and_b32 v42, v42, v43
    v_and_b32 v40, v40, v42
    v_cmp_ne_u32 vcc, 1, v40
    s_cbranch_vccz L_a_uok2
    s_sleep 8
    s_sub_u32 s66, s66, 1
    s_cmp_lg_u32 s66, 0
    s_cbranch_scc1 L_a_upoll
L_a_uok2:
    ds_write_b32 v2, v18 offset:224
L_a_uw:
    s_mov_b32 s66, 160000
L_lw32:
    ds_read_b32 v40, v2 offset:224
    s_waitcnt lgkmcnt(0)
    v_cmp_gt_u32 vcc, 1, v40
    s_cbranch_vccz L_lw32_ok
    s_sleep 8
    s_sub_u32 s66, s66, 1
    s_cmp_lg_u32 s66, 0
    s_cbranch_scc1 L_lw32
L_lw32_ok:
    s_nop 0
    buffer_load_dwordx4 v[96:99], v7, s[48:51], 0 offen offset:3584
    buffer_load_dwordx4 v[100:103], v7, s[48:51], 0 offen offset:3072
    buffer_load_dwordx4 v[104:107], v7, s[48:51], 0 offen offset:2560
    buffer_load_dwordx4 v[108:111], v7, s[48:51], 0 offen offset:2048
    buffer_load_dwordx4 v[112:115], v7, s[48:51], 0 offen offset:1536
    buffer_load_dwordx4 v[116:119], v7, s[48:51], 0 offen offset:1024
    buffer_load_dwordx4 v[120:123], v7, s[48:51], 0 offen offset:512
    buffer_load_dwordx4 v[124:127], v7, s[48:51], 0 offen offset:0
    buffer_load_dwordx4 v[60:63], v4, s[48:51], 0 offen offset:192
    buffer_load_dwordx4 v[56:59], v4, s[48:51], 0 offen offset:704
    buffer_load_dwordx4 v[52:55], v4, s[48:51], 0 offen offset:1216
    buffer_load_dwordx4 v[48:51], v4, s[48:51], 0 offen offset:1728
    buffer_load_dwordx4 v[44:47], v4, s[48:51], 0 offen offset:2240
    buffer_load_dwordx4 v[40:43], v4, s[48:51], 0 offen offset:2752
    buffer_load_dwordx4 v[36:39], v4, s[48:51], 0 offen offset:3264
    buffer_load_dwordx4 v[32:35], v4, s[48:51], 0 offen offset:3776
    s_waitcnt vmcnt(24)
    v_lshlrev_b32 v22, v20, v22
    v_cmp_eq_u32 vcc, 0, v11
    s_nop 1
    v_cndmask_b32 v12, 0, v22, vcc
    v_cmp_eq_u32 vcc, 1, v11
    s_nop 1
    v_cndmask_b32 v13, 0, v22, vcc
    v_cmp_eq_u32 vcc, 2, v11
    s_nop 1
    v_cndmask_b32 v14, 0, v22, vcc
    v_cmp_eq_u32 vcc, 3, v11
    s_nop 1
    v_cndmask_b32 v15, 0, v22, vcc
    s_waitcnt vmcnt(8)
    s_nop 1
    s_setprio 1
    s_nop 0
    v_mfma_f32_16x16x32_bf16 v[128:131], v[12:15], v[96:99], 0
    v_mfma_f32_16x16x32_bf16 v[132:135], v[12:15], v[100:103], 0
    v_mfma_f32_16x16x32_bf16 v[136:139], v[12:15], v[104:107], 0
    v_mfma_f32_16x16x32_bf16 v[140:143], v[12:15], v[108:111], 0
    v_mfma_f32_16x16x32_bf16 v[144:147], v[12:15], v[112:115], 0
    v_mfma_f32_16x16x32_bf16 v[148:151], v[12:15], v[116:119], 0
    v_mfma_f32_16x16x32_bf16 v[152:155], v[12:15], v[120:123], 0
    v_mfma_f32_16x16x32_bf16 v[156:159], v[12:15], v[124:127], 0
    buffer_load_dwordx4 v[96:99], v29, s[44:47], 0 offen
    buffer_load_dwordx4 v[100:103], v5, s[44:47], 0 offen offset:128
    buffer_load_dwordx4 v[104:107], v5, s[44:47], 0 offen offset:640
    buffer_load_dwordx4 v[108:111], v5, s[44:47], 0 offen offset:1152
    buffer_load_dwordx4 v[112:115], v5, s[44:47], 0 offen offset:1664
    buffer_load_dwordx4 v[116:119], v5, s[44:47], 0 offen offset:2176
    buffer_load_dwordx4 v[120:123], v5, s[44:47], 0 offen offset:2688
    buffer_load_dwordx4 v[124:127], v5, s[44:47], 0 offen offset:3200
    s_waitcnt vmcnt(8)
    s_nop 0
    v_mfma_f32_16x16x32_bf16 v[156:159], v[60:63], v[64:67], v[156:159]
    buffer_load_dwordx4 v[60:63], v4, s[48:51], 0 offen offset:128
    v_mfma_f32_16x16x32_bf16 v[152:155], v[56:59], v[64:67], v[152:155]
    v_mfma_f32_16x16x32_bf16 v[156:159], v[56:59], v[68:71], v[156:159]
    buffer_load_dwordx4 v[56:59], v4, s[48:51], 0 offen offset:640
    v_mfma_f32_16x16x32_bf16 v[148:151], v[52:55], v[64:67], v[148:151]
    v_mfma_f32_16x16x32_bf16 v[152:155], v[52:55], v[68:71], v[152:155]
    v_mfma_f32_16x16x32_bf16 v[156:159], v[52:55], v[72:75], v[156:159]
    buffer_load_dwordx4 v[52:55], v4, s[48:51], 0 offen offset:1152
    v_mfma_f32_16x16x32_bf16 v[144:147], v[48:51], v[64:67], v[144:147]
    v_mfma_f32_16x16x32_bf16 v[148:151], v[48:51], v[68:71], v[148:151]
    v_mfma_f32_16x16x32_bf16 v[152:155], v[48:51], v[72:75], v[152:155]
    v_mfma_f32_16x16x32_bf16 v[156:159], v[48:51], v[76:79], v[156:159]
    buffer_load_dwordx4 v[48:51], v4, s[48:51], 0 offen offset:1664
    v_mfma_f32_16x16x32_bf16 v[140:143], v[44:47], v[64:67], v[140:143]
    v_mfma_f32_16x16x32_bf16 v[144:147], v[44:47], v[68:71], v[144:147]
    v_mfma_f32_16x16x32_bf16 v[148:151], v[44:47], v[72:75], v[148:151]
    v_mfma_f32_16x16x32_bf16 v[152:155], v[44:47], v[76:79], v[152:155]
    v_mfma_f32_16x16x32_bf16 v[156:159], v[44:47], v[80:83], v[156:159]
    buffer_load_dwordx4 v[44:47], v4, s[48:51], 0 offen offset:2176
    v_mfma_f32_16x16x32_bf16 v[136:139], v[40:43], v[64:67], v[136:139]
    v_mfma_f32_16x16x32_bf16 v[140:143], v[40:43], v[68:71], v[140:143]
    v_mfma_f32_16x16x32_bf16 v[144:147], v[40:43], v[72:75], v[144:147]
    v_mfma_f32_16x16x32_bf16 v[148:151], v[40:43], v[76:79], v[148:151]
    v_mfma_f32_16x16x32_bf16 v[152:155], v[40:43], v[80:83], v[152:155]
    v_mfma_f32_16x16x32_bf16 v[156:159], v[40:43], v[84:87], v[156:159]
    buffer_load_dwordx4 v[40:43], v4, s[48:51], 0 offen offset:2688
    v_mfma_f32_16x16x32_bf16 v[132:135], v[36:39], v[64:67], v[132:135]
    v_mfma_f32_16x16x32_bf16 v[136:139], v[36:39], v[68:71], v[136:139]
    v_mfma_f32_16x16x32_bf16 v[140:143], v[36:39], v[72:75], v[140:143]
    v_mfma_f32_16x16x32_bf16 v[144:147], v[36:39], v[76:79], v[144:147]
    v_mfma_f32_16x16x32_bf16 v[148:151], v[36:39], v[80:83], v[148:151]
    v_mfma_f32_16x16x32_bf16 v[152:155], v[36:39], v[84:87], v[152:155]
    v_mfma_f32_16x16x32_bf16 v[156:159], v[36:39], v[88:91], v[156:159]
    buffer_load_dwordx4 v[36:39], v4, s[48:51], 0 offen offset:3200
    v_mfma_f32_16x16x32_bf16 v[128:131], v[32:35], v[64:67], v[128:131]
    v_mfma_f32_16x16x32_bf16 v[132:135], v[32:35], v[68:71], v[132:135]
    v_mfma_f32_16x16x32_bf16 v[136:139], v[32:35], v[72:75], v[136:139]
    v_mfma_f32_16x16x32_bf16 v[140:143], v[32:35], v[76:79], v[140:143]
    v_mfma_f32_16x16x32_bf16 v[144:147], v[32:35], v[80:83], v[144:147]
    v_mfma_f32_16x16x32_bf16 v[148:151], v[32:35], v[84:87], v[148:151]
    v_mfma_f32_16x16x32_bf16 v[152:155], v[32:35], v[88:91], v[152:155]
    v_mfma_f32_16x16x32_bf16 v[156:159], v[32:35], v[92:95], v[156:159]
    buffer_load_dwordx4 v[32:35], v4, s[48:51], 0 offen offset:3712
    buffer_load_dwordx4 v[64:67], v30, s[44:47], 0 offen
    buffer_load_dwordx4 v[68:71], v5, s[44:47], 0 offen offset:64
    buffer_load_dwordx4 v[72:75], v5, s[44:47], 0 offen offset:576
    buffer_load_dwordx4 v[76:79], v5, s[44:47], 0 offen offset:1088
    buffer_load_dwordx4 v[80:83], v5, s[44:47], 0 offen offset:1600
    buffer_load_dwordx4 v[84:87], v5, s[44:47], 0 offen offset:2112
    buffer_load_dwordx4 v[88:91], v5, s[44:47], 0 offen offset:2624
    buffer_load_dwordx4 v[92:95], v5, s[44:47], 0 offen offset:3136
    s_waitcnt vmcnt(8)
    s_nop 0
    v_mfma_f32_16x16x32_bf16 v[156:159], v[60:63], v[96:99], v[156:159]
    buffer_load_dwordx4 v[60:63], v4, s[48:51], 0 offen offset:64
    v_mfma_f32_16x16x32_bf16 v[152:155], v[56:59], v[96:99], v[152:155]
    v_mfma_f32_16x16x32_bf16 v[156:159], v[56:59], v[100:103], v[156:159]
    buffer_load_dwordx4 v[56:59], v4, s[48:51], 0 offen offset:576
    v_mfma_f32_16x16x32_bf16 v[148:151], v[52:55], v[96:99], v[148:151]
    v_mfma_f32_16x16x32_bf16 v[152:155], v[52:55], v[100:103], v[152:155]
    v_mfma_f32_16x16x32_bf16 v[156:159], v[52:55], v[104:107], v[156:159]
    buffer_load_dwordx4 v[52:55], v4, s[48:51], 0 offen offset:1088
    v_mfma_f32_16x16x32_bf16 v[144:147], v[48:51], v[96:99], v[144:147]
    v_mfma_f32_16x16x32_bf16 v[148:151], v[48:51], v[100:103], v[148:151]
    v_mfma_f32_16x16x32_bf16 v[152:155], v[48:51], v[104:107], v[152:155]
    v_mfma_f32_16x16x32_bf16 v[156:159], v[48:51], v[108:111], v[156:159]
    buffer_load_dwordx4 v[48:51], v4, s[48:51], 0 offen offset:1600
    v_mfma_f32_16x16x32_bf16 v[140:143], v[44:47], v[96:99], v[140:143]
    v_mfma_f32_16x16x32_bf16 v[144:147], v[44:47], v[100:103], v[144:147]
    v_mfma_f32_16x16x32_bf16 v[148:151], v[44:47], v[104:107], v[148:151]
    v_mfma_f32_16x16x32_bf16 v[152:155], v[44:47], v[108:111], v[152:155]
    v_mfma_f32_16x16x32_bf16 v[156:159], v[44:47], v[112:115], v[156:159]
    buffer_load_dwordx4 v[44:47], v4, s[48:51], 0 offen offset:2112
    v_mfma_f32_16x16x32_bf16 v[136:139], v[40:43], v[96:99], v[136:139]
    v_mfma_f32_16x16x32_bf16 v[140:143], v[40:43], v[100:103], v[140:143]
    v_mfma_f32_16x16x32_bf16 v[144:147], v[40:43], v[104:107], v[144:147]
    v_mfma_f32_16x16x32_bf16 v[148:151], v[40:43], v[108:111], v[148:151]
    v_mfma_f32_16x16x32_bf16 v[152:155], v[40:43], v[112:115], v[152:155]
    v_mfma_f32_16x16x32_bf16 v[156:159], v[40:43], v[116:119], v[156:159]
    buffer_load_dwordx4 v[40:43], v4, s[48:51], 0 offen offset:2624
    v_mfma_f32_16x16x32_bf16 v[132:135], v[36:39], v[96:99], v[132:135]
    v_mfma_f32_16x16x32_bf16 v[136:139], v[36:39], v[100:103], v[136:139]
    v_mfma_f32_16x16x32_bf16 v[140:143], v[36:39], v[104:107], v[140:143]
    v_mfma_f32_16x16x32_bf16 v[144:147], v[36:39], v[108:111], v[144:147]
    v_mfma_f32_16x16x32_bf16 v[148:151], v[36:39], v[112:115], v[148:151]
    v_mfma_f32_16x16x32_bf16 v[152:155], v[36:39], v[116:119], v[152:155]
    v_mfma_f32_16x16x32_bf16 v[156:159], v[36:39], v[120:123], v[156:159]
    buffer_load_dwordx4 v[36:39], v4, s[48:51], 0 offen offset:3136
    v_mfma_f32_16x16x32_bf16 v[128:131], v[32:35], v[96:99], v[128:131]
    v_mfma_f32_16x16x32_bf16 v[132:135], v[32:35], v[100:103], v[132:135]
    v_mfma_f32_16x16x32_bf16 v[136:139], v[32:35], v[104:107], v[136:139]
    v_mfma_f32_16x16x32_bf16 v[140:143], v[32:35], v[108:111], v[140:143]
    v_mfma_f32_16x16x32_bf16 v[144:147], v[32:35], v[112:115], v[144:147]
    v_mfma_f32_16x16x32_bf16 v[148:151], v[32:35], v[116:119], v[148:151]
    v_mfma_f32_16x16x32_bf16 v[152:155], v[32:35], v[120:123], v[152:155]
    v_mfma_f32_16x16x32_bf16 v[156:159], v[32:35], v[124:127], v[156:159]
    buffer_load_dwordx4 v[32:35], v4, s[48:51], 0 offen offset:3648
    buffer_load_dwordx4 v[96:99], v31, s[44:47], 0 offen
    buffer_load_dwordx4 v[100:103], v5, s[44:47], 0 offen offset:0
    buffer_load_dwordx4 v[104:107], v5, s[44:47], 0 offen offset:512
    buffer_load_dwordx4 v[108:111], v5, s[44:47], 0 offen offset:1024
    buffer_load_dwordx4 v[112:115], v5, s[44:47], 0 offen offset:1536
    buffer_load_dwordx4 v[116:119], v5, s[44:47], 0 offen offset:2048
    buffer_load_dwordx4 v[120:123], v5, s[44:47], 0 offen offset:2560
    buffer_load_dwordx4 v[124:127], v5, s[44:47], 0 offen offset:3072
    s_waitcnt vmcnt(8)
    s_nop 0
    v_mfma_f32_16x16x32_bf16 v[156:159], v[60:63], v[64:67], v[156:159]
    buffer_load_dwordx4 v[60:63], v4, s[48:51], 0 offen offset:0
    v_mfma_f32_16x16x32_bf16 v[152:155], v[56:59], v[64:67], v[152:155]
    v_mfma_f32_16x16x32_bf16 v[156:159], v[56:59], v[68:71], v[156:159]
    buffer_load_dwordx4 v[56:59], v4, s[48:51], 0 offen offset:512
    v_mfma_f32_16x16x32_bf16 v[148:151], v[52:55], v[64:67], v[148:151]
    v_mfma_f32_16x16x32_bf16 v[152:155], v[52:55], v[68:71], v[152:155]
    v_mfma_f32_16x16x32_bf16 v[156:159], v[52:55], v[72:75], v[156:159]
    buffer_load_dwordx4 v[52:55], v4, s[48:51], 0 offen offset:1024
    v_mfma_f32_16x16x32_bf16 v[144:147], v[48:51], v[64:67], v[144:147]
    v_mfma_f32_16x16x32_bf16 v[148:151], v[48:51], v[68:71], v[148:151]
    v_mfma_f32_16x16x32_bf16 v[152:155], v[48:51], v[72:75], v[152:155]
    v_mfma_f32_16x16x32_bf16 v[156:159], v[48:51], v[76:79], v[156:159]
    buffer_load_dwordx4 v[48:51], v4, s[48:51], 0 offen offset:1536
    v_mfma_f32_16x16x32_bf16 v[140:143], v[44:47], v[64:67], v[140:143]
    v_mfma_f32_16x16x32_bf16 v[144:147], v[44:47], v[68:71], v[144:147]
    v_mfma_f32_16x16x32_bf16 v[148:151], v[44:47], v[72:75], v[148:151]
    v_mfma_f32_16x16x32_bf16 v[152:155], v[44:47], v[76:79], v[152:155]
    v_mfma_f32_16x16x32_bf16 v[156:159], v[44:47], v[80:83], v[156:159]
    buffer_load_dwordx4 v[44:47], v4, s[48:51], 0 offen offset:2048
    v_mfma_f32_16x16x32_bf16 v[136:139], v[40:43], v[64:67], v[136:139]
    v_mfma_f32_16x16x32_bf16 v[140:143], v[40:43], v[68:71], v[140:143]
    v_mfma_f32_16x16x32_bf16 v[144:147], v[40:43], v[72:75], v[144:147]
    v_mfma_f32_16x16x32_bf16 v[148:151], v[40:43], v[76:79], v[148:151]
    v_mfma_f32_16x16x32_bf16 v[152:155], v[40:43], v[80:83], v[152:155]
    v_mfma_f32_16x16x32_bf16 v[156:159], v[40:43], v[84:87], v[156:159]
    buffer_load_dwordx4 v[40:43], v4, s[48:51], 0 offen offset:2560
    v_mfma_f32_16x16x32_bf16 v[132:135], v[36:39], v[64:67], v[132:135]
    v_mfma_f32_16x16x32_bf16 v[136:139], v[36:39], v[68:71], v[136:139]
    v_mfma_f32_16x16x32_bf16 v[140:143], v[36:39], v[72:75], v[140:143]
    v_mfma_f32_16x16x32_bf16 v[144:147], v[36:39], v[76:79], v[144:147]
    v_mfma_f32_16x16x32_bf16 v[148:151], v[36:39], v[80:83], v[148:151]
    v_mfma_f32_16x16x32_bf16 v[152:155], v[36:39], v[84:87], v[152:155]
    v_mfma_f32_16x16x32_bf16 v[156:159], v[36:39], v[88:91], v[156:159]
    buffer_load_dwordx4 v[36:39], v4, s[48:51], 0 offen offset:3072
    v_mfma_f32_16x16x32_bf16 v[128:131], v[32:35], v[64:67], v[128:131]
    v_mfma_f32_16x16x32_bf16 v[132:135], v[32:35], v[68:71], v[132:135]
    v_mfma_f32_16x16x32_bf16 v[136:139], v[32:35], v[72:75], v[136:139]
    v_mfma_f32_16x16x32_bf16 v[140:143], v[32:35], v[76:79], v[140:143]
    v_mfma_f32_16x16x32_bf16 v[144:147], v[32:35], v[80:83], v[144:147]
    v_mfma_f32_16x16x32_bf16 v[148:151], v[32:35], v[84:87], v[148:151]
    v_mfma_f32_16x16x32_bf16 v[152:155], v[32:35], v[88:91], v[152:155]
    v_mfma_f32_16x16x32_bf16 v[156:159], v[32:35], v[92:95], v[156:159]
    buffer_load_dwordx4 v[32:35], v4, s[48:51], 0 offen offset:3584
    s_waitcnt vmcnt(0)
    s_nop 0
    v_mfma_f32_16x16x32_bf16 v[156:159], v[60:63], v[96:99], v[156:159]
    v_mfma_f32_16x16x32_bf16 v[152:155], v[56:59], v[96:99], v[152:155]
    v_mfma_f32_16x16x32_bf16 v[156:159], v[56:59], v[100:103], v[156:159]
    v_mfma_f32_16x16x32_bf16 v[148:151], v[52:55], v[96:99], v[148:151]
    v_mfma_f32_16x16x32_bf16 v[152:155], v[52:55], v[100:103], v[152:155]
    v_mfma_f32_16x16x32_bf16 v[156:159], v[52:55], v[104:107], v[156:159]
    v_mfma_f32_16x16x32_bf16 v[144:147], v[48:51], v[96:99], v[144:147]
    v_mfma_f32_16x16x32_bf16 v[148:151], v[48:51], v[100:103], v[148:151]
    v_mfma_f32_16x16x32_bf16 v[152:155], v[48:51], v[104:107], v[152:155]
    v_mfma_f32_16x16x32_bf16 v[156:159], v[48:51], v[108:111], v[156:159]
    v_mfma_f32_16x16x32_bf16 v[140:143], v[44:47], v[96:99], v[140:143]
    v_mfma_f32_16x16x32_bf16 v[144:147], v[44:47], v[100:103], v[144:147]
    v_mfma_f32_16x16x32_bf16 v[148:151], v[44:47], v[104:107], v[148:151]
    v_mfma_f32_16x16x32_bf16 v[152:155], v[44:47], v[108:111], v[152:155]
    v_mfma_f32_16x16x32_bf16 v[156:159], v[44:47], v[112:115], v[156:159]
    v_mfma_f32_16x16x32_bf16 v[136:139], v[40:43], v[96:99], v[136:139]
    v_mfma_f32_16x16x32_bf16 v[140:143], v[40:43], v[100:103], v[140:143]
    v_mfma_f32_16x16x32_bf16 v[144:147], v[40:43], v[104:107], v[144:147]
    v_mfma_f32_16x16x32_bf16 v[148:151], v[40:43], v[108:111], v[148:151]
    v_mfma_f32_16x16x32_bf16 v[152:155], v[40:43], v[112:115], v[152:155]
    v_mfma_f32_16x16x32_bf16 v[156:159], v[40:43], v[116:119], v[156:159]
    v_mfma_f32_16x16x32_bf16 v[132:135], v[36:39], v[96:99], v[132:135]
    v_mfma_f32_16x16x32_bf16 v[136:139], v[36:39], v[100:103], v[136:139]
    v_mfma_f32_16x16x32_bf16 v[140:143], v[36:39], v[104:107], v[140:143]
    v_mfma_f32_16x16x32_bf16 v[144:147], v[36:39], v[108:111], v[144:147]
    v_mfma_f32_16x16x32_bf16 v[148:151], v[36:39], v[112:115], v[148:151]
    v_mfma_f32_16x16x32_bf16 v[152:155], v[36:39], v[116:119], v[152:155]
    v_mfma_f32_16x16x32_bf16 v[156:159], v[36:39], v[120:123], v[156:159]
    v_mfma_f32_16x16x32_bf16 v[128:131], v[32:35], v[96:99], v[128:131]
    v_mfma_f32_16x16x32_bf16 v[132:135], v[32:35], v[100:103], v[132:135]
    v_mfma_f32_16x16x32_bf16 v[136:139], v[32:35], v[104:107], v[136:139]
    v_mfma_f32_16x16x32_bf16 v[140:143], v[32:35], v[108:111], v[140:143]
    v_mfma_f32_16x16x32_bf16 v[144:147], v[32:35], v[112:115], v[144:147]
    v_mfma_f32_16x16x32_bf16 v[148:151], v[32:35], v[116:119], v[148:151]
    v_mfma_f32_16x16x32_bf16 v[152:155], v[32:35], v[120:123], v[152:155]
    v_mfma_f32_16x16x32_bf16 v[156:159], v[32:35], v[124:127], v[156:159]
    s_setprio 3
    s_nop 0
    s_mul_i32 s64, s5, 72
    s_lshr_b32 s60, s4, 2
    s_add_u32 s64, s64, s60
    s_add_u32 s64, s64, 64
    s_lshl_b32 s60, s64, 12
    s_add_u32 s44, s26, s60
    s_addc_u32 s45, s27, 0
    s_and_b32 s45, s45, 0xffff
    s_mov_b32 s46, 4096
    s_mov_b32 s47, 0x00020000
    s_mul_i32 s60, s64, 8448
    s_add_u32 s60, s60, 2686976
    s_add_u32 s48, s36, s60
    s_addc_u32 s49, s37, 0
    s_and_b32 s49, s49, 0xffff
    s_mov_b32 s50, 8448
    s_mov_b32 s51, 0x00020000
    s_lshl_b32 s60, s64, 1
    v_mov_b32 v21, s60
    s_and_b32 s71, s4, 3
    s_lshl_b32 s71, s71, 9
    s_sub_u32 s72, 3584, s71
    s_lshl_b32 s60, s6, 7
    s_nop 0
    s_add_u32 s61, s60, 3648
    v_subrev_u32 v4, s61, v26
    v_subrev_u32 v27, s60, v27
    v_subrev_u32_e64 v29, 64, v27
    v_add_u32 v5, 448, v27
    buffer_load_ushort v22, v21, s[52:55], 0 offen
    buffer_load_dwordx4 v[32:35], v4, s[48:51], 0 offen offset:3648
    buffer_load_dwordx4 v[64:67], v27, s[44:47], 0 offen
    buffer_load_dwordx4 v[36:39], v4, s[48:51], 0 offen offset:3136
    buffer_load_dwordx4 v[68:71], v5, s[44:47], 0 offen offset:64
    buffer_load_dwordx4 v[40:43], v4, s[48:51], 0 offen offset:2624
    buffer_load_dwordx4 v[72:75], v5, s[44:47], 0 offen offset:576
    buffer_load_dwordx4 v[44:47], v4, s[48:51], 0 offen offset:2112
    buffer_load_dwordx4 v[76:79], v5, s[44:47], 0 offen offset:1088
    buffer_load_dwordx4 v[48:51], v4, s[48:51], 0 offen offset:1600
    buffer_load_dwordx4 v[80:83], v5, s[44:47], 0 offen offset:1600
    s_cmp_lt_u32 s72, 2560
    s_cbranch_scc1 L_a_ul0
    s_nop 0
    buffer_load_dwordx4 v[52:55], v4, s[48:51], 0 offen offset:1088
    buffer_load_dwordx4 v[84:87], v5, s[44:47], 0 offen offset:2112
    s_cmp_lt_u32 s72, 3072
    s_cbranch_scc1 L_a_ul0
    s_nop 0
    buffer_load_dwordx4 v[56:59], v4, s[48:51], 0 offen offset:576
    buffer_load_dwordx4 v[88:91], v5, s[44:47], 0 offen offset:2624
    s_cmp_lt_u32 s72, 3584
    s_cbranch_scc1 L_a_ul0
    s_nop 0
    buffer_load_dwordx4 v[60:63], v4, s[48:51], 0 offen offset:64
    buffer_load_dwordx4 v[92:95], v5, s[44:47], 0 offen offset:3136
L_a_ul0:
    s_mov_b32 s66, 160000
L_lw33:
    ds_read_b128 v[160:163], v2 offset:112
    s_waitcnt lgkmcnt(0)
    v_min_u32 v160, v160, v161
    v_min3_u32 v160, v160, v162, v163
    v_cmp_gt_u32 vcc, 1, v160
    s_cbranch_vccz L_lw33_ok
    s_sleep 1
    s_sub_u32 s66, s66, 1
    s_cmp_lg_u32 s66, 0
    s_cbranch_scc1 L_lw33
L_lw33_ok:
    v_xor_b32 v11, 2048, v6
    s_cmp_eq_u32 s70, 1
    s_cbranch_scc1 L_a_x1
    ds_write_b128 v6, v[144:147]
    ds_write_b128 v6, v[148:151] offset:1024
    v_mov_b32 v20, 1
    s_waitcnt lgkmcnt(0)
    ds_write_b32 v19, v20 offset:448
    s_mov_b32 s66, 160000
L_lw34:
    ds_read_b32 v160, v10 offset:448
    s_waitcnt lgkmcnt(0)
    v_cmp_gt_u32 vcc, 1, v160
    s_cbranch_vccz L_lw34_ok
    s_sub_u32 s66, s66, 1
    s_cmp_lg_u32 s66, 0
    s_cbranch_scc1 L_lw34
L_lw34_ok:
    ds_read_b128 v[160:163], v11
    ds_read_b128 v[164:167], v11 offset:1024
    s_waitcnt lgkmcnt(0)
    s_nop 0
    ds_write_b32 v19, v20 offset:464
    v_add_f32 v128, v128, v160
    v_add_f32 v129, v129, v161
    v_add_f32 v130, v130, v162
    v_add_f32 v131, v131, v163
    v_add_f32 v132, v132, v164
    v_add_f32 v133, v133, v165
    v_add_f32_e64 v134, v134, v166
    v_add_f32 v135, v135, v167
    s_nop 0
    v_permlane32_swap_b32 v128, v130
    v_permlane32_swap_b32 v129, v131
    v_cvt_pk_bf16_f32 v128, v128, v130
    v_cvt_pk_bf16_f32 v129, v129, v131
    buffer_store_dwordx2 v[128:129], v8, s[40:43], s67 offen offset:0 sc1
    s_nop 0
    v_permlane32_swap_b32 v132, v134
    v_permlane32_swap_b32 v133, v135
    s_nop 0
    v_cvt_pk_bf16_f32 v132, v132, v134
    v_cvt_pk_bf16_f32 v133, v133, v135
    buffer_store_dwordx2 v[132:133], v8, s[40:43], s67 offen offset:512 sc1
    s_mov_b32 s66, 160000
L_lw35:
    ds_read_b32 v160, v10 offset:464
    s_waitcnt lgkmcnt(0)
    v_cmp_gt_u32 vcc, 1, v160
    s_cbranch_vccz L_lw35_ok
    s_sub_u32 s66, s66, 1
    s_cmp_lg_u32 s66, 0
    s_cbranch_scc1 L_lw35
L_lw35_ok:
    ds_write_b128 v6, v[152:155]
    ds_write_b128 v6, v[156:159] offset:1024
    v_mov_b32 v20, 2
    s_waitcnt lgkmcnt(0)
    ds_write_b32 v19, v20 offset:448
    s_mov_b32 s66, 160000
L_lw36:
    ds_read_b32 v160, v10 offset:448
    s_waitcnt lgkmcnt(0)
    v_cmp_gt_u32 vcc, 2, v160
    s_cbranch_vccz L_lw36_ok
    s_sub_u32 s66, s66, 1
    s_cmp_lg_u32 s66, 0
    s_cbranch_scc1 L_lw36
L_lw36_ok:
    ds_read_b128 v[160:163], v11
    ds_read_b128 v[164:167], v11 offset:1024
    s_waitcnt lgkmcnt(0)
    s_nop 0
    ds_write_b32 v19, v20 offset:464
    v_add_f32 v136, v136, v160
    v_add_f32 v137, v137, v161
    v_add_f32 v138, v138, v162
    v_add_f32 v139, v139, v163
    v_add_f32 v140, v140, v164
    v_add_f32 v141, v141, v165
    v_add_f32_e64 v142, v142, v166
    v_add_f32 v143, v143, v167
    s_nop 0
    v_permlane32_swap_b32 v136, v138
    v_permlane32_swap_b32 v137, v139
    v_cvt_pk_bf16_f32 v136, v136, v138
    v_cvt_pk_bf16_f32 v137, v137, v139
    buffer_store_dwordx2 v[136:137], v8, s[40:43], s67 offen offset:1024 sc1
    s_nop 0
    v_permlane32_swap_b32 v140, v142
    v_permlane32_swap_b32 v141, v143
    s_nop 0
    v_cvt_pk_bf16_f32 v140, v140, v142
    v_cvt_pk_bf16_f32 v141, v141, v143
    buffer_store_dwordx2 v[140:141], v8, s[40:43], s67 offen offset:1536 sc1
    s_branch L_a_xd
L_a_x1:
    s_nop 0
    ds_write_b128 v6, v[128:131]
    ds_write_b128 v6, v[132:135] offset:1024
    v_mov_b32 v20, 1
    s_waitcnt lgkmcnt(0)
    ds_write_b32 v19, v20 offset:448
    s_mov_b32 s66, 160000
L_lw37:
    ds_read_b32 v160, v10 offset:448
    s_waitcnt lgkmcnt(0)
    v_cmp_gt_u32 vcc, 1, v160
    s_cbranch_vccz L_lw37_ok
    s_sub_u32 s66, s66, 1
    s_cmp_lg_u32 s66, 0
    s_cbranch_scc1 L_lw37
L_lw37_ok:
    ds_read_b128 v[160:163], v11
    ds_read_b128 v[164:167], v11 offset:1024
    s_waitcnt lgkmcnt(0)
    s_nop 0
    ds_write_b32 v19, v20 offset:464
    v_add_f32 v144, v144, v160
    v_add_f32 v145, v145, v161
    v_add_f32 v146, v146, v162
    v_add_f32 v147, v147, v163
    v_add_f32 v148, v148, v164
    v_add_f32 v149, v149, v165
    v_add_f32_e64 v150, v150, v166
    v_add_f32 v151, v151, v167
    s_nop 0
    v_permlane32_swap_b32 v144, v146
    v_permlane32_swap_b32 v145, v147
    v_cvt_pk_bf16_f32 v144, v144, v146
    v_cvt_pk_bf16_f32 v145, v145, v147
    buffer_store_dwordx2 v[144:145], v8, s[40:43], s67 offen offset:2048 sc1
    s_nop 0
    v_permlane32_swap_b32 v148, v150
    v_permlane32_swap_b32 v149, v151
    s_nop 0
    v_cvt_pk_bf16_f32 v148, v148, v150
    v_cvt_pk_bf16_f32 v149, v149, v151
    buffer_store_dwordx2 v[148:149], v8, s[40:43], s67 offen offset:2560 sc1
    s_mov_b32 s66, 160000
L_lw38:
    ds_read_b32 v160, v10 offset:464
    s_waitcnt lgkmcnt(0)
    v_cmp_gt_u32 vcc, 1, v160
    s_cbranch_vccz L_lw38_ok
    s_sub_u32 s66, s66, 1
    s_cmp_lg_u32 s66, 0
    s_cbranch_scc1 L_lw38
L_lw38_ok:
    ds_write_b128 v6, v[136:139]
    ds_write_b128 v6, v[140:143] offset:1024
    v_mov_b32 v20, 2
    s_waitcnt lgkmcnt(0)
    ds_write_b32 v19, v20 offset:448
    s_mov_b32 s66, 160000
L_lw39:
    ds_read_b32 v160, v10 offset:448
    s_waitcnt lgkmcnt(0)
    v_cmp_gt_u32 vcc, 2, v160
    s_cbranch_vccz L_lw39_ok
    s_sub_u32 s66, s66, 1
    s_cmp_lg_u32 s66, 0
    s_cbranch_scc1 L_lw39
L_lw39_ok:
    ds_read_b128 v[160:163], v11
    ds_read_b128 v[164:167], v11 offset:1024
    s_waitcnt lgkmcnt(0)
    s_nop 0
    ds_write_b32 v19, v20 offset:464
    v_add_f32 v152, v152, v160
    v_add_f32 v153, v153, v161
    v_add_f32 v154, v154, v162
    v_add_f32 v155, v155, v163
    v_add_f32 v156, v156, v164
    v_add_f32 v157, v157, v165
    v_add_f32_e64 v158, v158, v166
    v_add_f32 v159, v159, v167
    s_nop 0
    v_permlane32_swap_b32 v152, v154
    v_permlane32_swap_b32 v153, v155
    v_cvt_pk_bf16_f32 v152, v152, v154
    v_cvt_pk_bf16_f32 v153, v153, v155
    buffer_store_dwordx2 v[152:153], v8, s[40:43], s67 offen offset:3072 sc1
    s_nop 0
    v_permlane32_swap_b32 v156, v158
    v_permlane32_swap_b32 v157, v159
    s_nop 0
    v_cvt_pk_bf16_f32 v156, v156, v158
    v_cvt_pk_bf16_f32 v157, v157, v159
    buffer_store_dwordx2 v[156:157], v8, s[40:43], s67 offen offset:3584 sc1
L_a_xd:
    buffer_load_dwordx4 v[96:99], v4, s[48:51], 0 offen offset:3584
    buffer_load_dwordx4 v[128:131], v29, s[44:47], 0 offen
    buffer_load_dwordx4 v[100:103], v4, s[48:51], 0 offen offset:3072
    buffer_load_dwordx4 v[132:135], v5, s[44:47], 0 offen offset:0
    buffer_load_dwordx4 v[104:107], v4, s[48:51], 0 offen offset:2560
    buffer_load_dwordx4 v[136:139], v5, s[44:47], 0 offen offset:512
    buffer_load_dwordx4 v[108:111], v4, s[48:51], 0 offen offset:2048
    buffer_load_dwordx4 v[140:143], v5, s[44:47], 0 offen offset:1024
    buffer_load_dwordx4 v[112:115], v4, s[48:51], 0 offen offset:1536
    buffer_load_dwordx4 v[144:147], v5, s[44:47], 0 offen offset:1536
    s_cmp_lt_u32 s72, 2560
    s_cbranch_scc1 L_a_ul1
    s_nop 0
    buffer_load_dwordx4 v[116:119], v4, s[48:51], 0 offen offset:1024
    buffer_load_dwordx4 v[148:151], v5, s[44:47], 0 offen offset:2048
    s_cmp_lt_u32 s72, 3072
    s_cbranch_scc1 L_a_ul1
    s_nop 0
    buffer_load_dwordx4 v[120:123], v4, s[48:51], 0 offen offset:512
    buffer_load_dwordx4 v[152:155], v5, s[44:47], 0 offen offset:2560
    s_cmp_lt_u32 s72, 3584
    s_cbranch_scc1 L_a_ul1
    s_nop 0
    buffer_load_dwordx4 v[124:127], v4, s[48:51], 0 offen offset:0
    buffer_load_dwordx4 v[156:159], v5, s[44:47], 0 offen offset:3072
L_a_ul1:
    s_cmp_eq_u32 s6, 0
    s_cselect_b32 s73, s71, s72
    v_sub_u32 v11, 4088, v8
    v_subrev_u32_e64 v11, s73, v11
    buffer_load_dwordx2 v[12:13], v11, s[48:51], 0 offen
    s_setprio 1
    s_cmp_eq_u32 s71, 0
    s_cbranch_scc0 L_a_uv1
    s_waitcnt vmcnt(17)
    v_mfma_f32_16x16x32_bf16 v[164:167], v[32:35], v[92:95], 0
    v_mfma_f32_16x16x32_bf16 v[164:167], v[36:39], v[88:91], v[164:167]
    v_mfma_f32_16x16x32_bf16 v[164:167], v[40:43], v[84:87], v[164:167]
    v_mfma_f32_16x16x32_bf16 v[164:167], v[44:47], v[80:83], v[164:167]
    v_mfma_f32_16x16x32_bf16 v[164:167], v[48:51], v[76:79], v[164:167]
    v_mfma_f32_16x16x32_bf16 v[164:167], v[52:55], v[72:75], v[164:167]
    v_mfma_f32_16x16x32_bf16 v[164:167], v[56:59], v[68:71], v[164:167]
    v_mfma_f32_16x16x32_bf16 v[164:167], v[60:63], v[64:67], v[164:167]
    v_mfma_f32_16x16x32_bf16 v[160:163], v[32:35], v[64:67], 0
    s_waitcnt vmcnt(1)
    s_nop 0
    v_mfma_f32_16x16x32_bf16 v[164:167], v[96:99], v[156:159], v[164:167]
    v_mfma_f32_16x16x32_bf16 v[164:167], v[100:103], v[152:155], v[164:167]
    v_mfma_f32_16x16x32_bf16 v[164:167], v[104:107], v[148:151], v[164:167]
    v_mfma_f32_16x16x32_bf16 v[164:167], v[108:111], v[144:147], v[164:167]
    v_mfma_f32_16x16x32_bf16 v[164:167], v[112:115], v[140:143], v[164:167]
    v_mfma_f32_16x16x32_bf16 v[164:167], v[116:119], v[136:139], v[164:167]
    v_mfma_f32_16x16x32_bf16 v[164:167], v[120:123], v[132:135], v[164:167]
    v_mfma_f32_16x16x32_bf16 v[164:167], v[124:127], v[128:131], v[164:167]
    v_mfma_f32_16x16x32_bf16 v[160:163], v[96:99], v[128:131], v[160:163]
    s_branch L_a_uvd
L_a_uv1:
    s_nop 0
    s_cmp_eq_u32 s71, 512
    s_cbranch_scc0 L_a_uv2
    s_waitcnt vmcnt(15)
    v_mfma_f32_16x16x32_bf16 v[164:167], v[32:35], v[88:91], 0
    v_mfma_f32_16x16x32_bf16 v[164:167], v[36:39], v[84:87], v[164:167]
    v_mfma_f32_16x16x32_bf16 v[164:167], v[40:43], v[80:83], v[164:167]
    v_mfma_f32_16x16x32_bf16 v[164:167], v[44:47], v[76:79], v[164:167]
    v_mfma_f32_16x16x32_bf16 v[164:167], v[48:51], v[72:75], v[164:167]
    v_mfma_f32_16x16x32_bf16 v[164:167], v[52:55], v[68:71], v[164:167]
    v_mfma_f32_16x16x32_bf16 v[164:167], v[56:59], v[64:67], v[164:167]
    v_mfma_f32_16x16x32_bf16 v[160:163], v[32:35], v[68:71], 0
    v_mfma_f32_16x16x32_bf16 v[160:163], v[36:39], v[64:67], v[160:163]
    s_waitcnt vmcnt(1)
    s_nop 0
    v_mfma_f32_16x16x32_bf16 v[164:167], v[96:99], v[152:155], v[164:167]
    v_mfma_f32_16x16x32_bf16 v[164:167], v[100:103], v[148:151], v[164:167]
    v_mfma_f32_16x16x32_bf16 v[164:167], v[104:107], v[144:147], v[164:167]
    v_mfma_f32_16x16x32_bf16 v[164:167], v[108:111], v[140:143], v[164:167]
    v_mfma_f32_16x16x32_bf16 v[164:167], v[112:115], v[136:139], v[164:167]
    v_mfma_f32_16x16x32_bf16 v[164:167], v[116:119], v[132:135], v[164:167]
    v_mfma_f32_16x16x32_bf16 v[164:167], v[120:123], v[128:131], v[164:167]
    v_mfma_f32_16x16x32_bf16 v[160:163], v[96:99], v[132:135], v[160:163]
    v_mfma_f32_16x16x32_bf16 v[160:163], v[100:103], v[128:131], v[160:163]
    s_branch L_a_uvd
L_a_uv2:
    s_nop 0
    s_cmp_eq_u32 s71, 1024
    s_cbranch_scc0 L_a_uv3
    s_waitcnt vmcnt(13)
    v_mfma_f32_16x16x32_bf16 v[164:167], v[32:35], v[84:87], 0
    v_mfma_f32_16x16x32_bf16 v[164:167], v[36:39], v[80:83], v[164:167]
    v_mfma_f32_16x16x32_bf16 v[164:167], v[40:43], v[76:79], v[164:167]
    v_mfma_f32_16x16x32_bf16 v[164:167], v[44:47], v[72:75], v[164:167]
    v_mfma_f32_16x16x32_bf16 v[164:167], v[48:51], v[68:71], v[164:167]
    v_mfma_f32_16x16x32_bf16 v[164:167], v[52:55], v[64:67], v[164:167]
    v_mfma_f32_16x16x32_bf16 v[160:163], v[32:35], v[72:75], 0
    v_mfma_f32_16x16x32_bf16 v[160:163], v[36:39], v[68:71], v[160:163]
    v_mfma_f32_16x16x32_bf16 v[160:163], v[40:43], v[64:67], v[160:163]
    s_waitcnt vmcnt(1)
    s_nop 0
    v_mfma_f32_16x16x32_bf16 v[164:167], v[96:99], v[148:151], v[164:167]
    v_mfma_f32_16x16x32_bf16 v[164:167], v[100:103], v[144:147], v[164:167]
    v_mfma_f32_16x16x32_bf16 v[164:167], v[104:107], v[140:143], v[164:167]
    v_mfma_f32_16x16x32_bf16 v[164:167], v[108:111], v[136:139], v[164:167]
    v_mfma_f32_16x16x32_bf16 v[164:167], v[112:115], v[132:135], v[164:167]
    v_mfma_f32_16x16x32_bf16 v[164:167], v[116:119], v[128:131], v[164:167]
    v_mfma_f32_16x16x32_bf16 v[160:163], v[96:99], v[136:139], v[160:163]
    v_mfma_f32_16x16x32_bf16 v[160:163], v[100:103], v[132:135], v[160:163]
    v_mfma_f32_16x16x32_bf16 v[160:163], v[104:107], v[128:131], v[160:163]
    s_branch L_a_uvd
L_a_uv3:
    s_waitcnt vmcnt(11)
    v_mfma_f32_16x16x32_bf16 v[164:167], v[32:35], v[80:83], 0
    v_mfma_f32_16x16x32_bf16 v[164:167], v[36:39], v[76:79], v[164:167]
    v_mfma_f32_16x16x32_bf16 v[164:167], v[40:43], v[72:75], v[164:167]
    v_mfma_f32_16x16x32_bf16 v[164:167], v[44:47], v[68:71], v[164:167]
    v_mfma_f32_16x16x32_bf16 v[164:167], v[48:51], v[64:67], v[164:167]
    v_mfma_f32_16x16x32_bf16 v[160:163], v[32:35], v[76:79], 0
    v_mfma_f32_16x16x32_bf16 v[160:163], v[36:39], v[72:75], v[160:163]
    v_mfma_f32_16x16x32_bf16 v[160:163], v[40:43], v[68:71], v[160:163]
    v_mfma_f32_16x16x32_bf16 v[160:163], v[44:47], v[64:67], v[160:163]
    s_waitcnt vmcnt(1)
    s_nop 0
    v_mfma_f32_16x16x32_bf16 v[164:167], v[96:99], v[144:147], v[164:167]
    v_mfma_f32_16x16x32_bf16 v[164:167], v[100:103], v[140:143], v[164:167]
    v_mfma_f32_16x16x32_bf16 v[164:167], v[104:107], v[136:139], v[164:167]
    v_mfma_f32_16x16x32_bf16 v[164:167], v[108:111], v[132:135], v[164:167]
    v_mfma_f32_16x16x32_bf16 v[164:167], v[112:115], v[128:131], v[164:167]
    v_mfma_f32_16x16x32_bf16 v[160:163], v[96:99], v[140:143], v[160:163]
    v_mfma_f32_16x16x32_bf16 v[160:163], v[100:103], v[136:139], v[160:163]
    v_mfma_f32_16x16x32_bf16 v[160:163], v[104:107], v[132:135], v[160:163]
    v_mfma_f32_16x16x32_bf16 v[160:163], v[108:111], v[128:131], v[160:163]
L_a_uvd:
    s_setprio 3
    s_nop 1
    s_mov_b32 s66, 160000
L_lw40:
    ds_read_b32 v40, v10 offset:464
    s_waitcnt lgkmcnt(0)
    v_cmp_gt_u32 vcc, 2, v40
    s_cbranch_vccz L_lw40_ok
    s_sub_u32 s66, s66, 1
    s_cmp_lg_u32 s66, 0
    s_cbranch_scc1 L_lw40
L_lw40_ok:
    ds_write_b128 v6, v[160:163]
    ds_write_b128 v6, v[164:167] offset:1024
    s_lshl_b32 s60, s6, 10
    s_nop 0
    s_add_u32 s60, s60, 151552
    v_add_u32 v11, s60, v1
    s_lshl_b32 s67, s64, 12
    s_add_u32 s67, s67, 9961472
    s_add_u32 s67, s67, s73
    v_lshlrev_b32 v22, 16, v22
    s_waitcnt lgkmcnt(0)
    s_nop 0
    ds_write_b32 v19, v18 offset:480
    s_cmp_lt_u32 s6, 2
    s_cbranch_scc0 L_a_ydone
    s_mov_b32 s66, 160000
L_lw41:
    ds_read_b128 v[40:43], v2 offset:480
    s_waitcnt lgkmcnt(0)
    v_min_u32 v40, v40, v41
    v_min3_u32 v40, v40, v42, v43
    v_cmp_gt_u32 vcc, 1, v40
    s_cbranch_vccz L_lw41_ok
    s_sub_u32 s66, s66, 1
    s_cmp_lg_u32 s66, 0
    s_cbranch_scc1 L_lw41
L_lw41_ok:
    s_nop 0
    ds_read_b128 v[40:43], v11 offset:0
    ds_read_b128 v[44:47], v11 offset:2048
    ds_read_b128 v[48:51], v11 offset:4096
    ds_read_b128 v[52:55], v11 offset:6144
    s_waitcnt vmcnt(0) lgkmcnt(0)
    v_add_f32 v40, v40, v44
    v_add_f32 v41, v41, v45
    v_add_f32 v42, v42, v46
    v_add_f32 v43, v43, v47
    v_add_f32 v40, v40, v48
    v_add_f32 v41, v41, v49
    v_add_f32 v42, v42, v50
    v_add_f32 v43, v43, v51
    v_add_f32 v40, v40, v52
    v_add_f32 v41, v41, v53
    v_add_f32 v42, v42, v54
    v_add_f32_e64 v43, v43, v55
    v_and_b32 v56, 0xffff0000, v13
    v_lshlrev_b32_e64 v57, 16, v13
    v_permlane32_swap_b32 v40, v42
    v_permlane32_swap_b32 v41, v43
    v_and_b32 v58, 0xffff0000, v12
    v_lshlrev_b32 v59, 16, v12
    v_fmac_f32 v40, v22, v56
    v_fmac_f32 v42, v22, v57
    v_fmac_f32 v41, v22, v58
    v_fmac_f32_e64 v43, v22, v59
    v_cvt_pk_bf16_f32 v40, v40, v42
    v_cvt_pk_bf16_f32 v41, v41, v43
    buffer_store_dwordx2 v[40:41], v8, s[40:43], s67 offen sc1
L_a_ydone:
    s_waitcnt vmcnt(0)
    s_nop 0
    ds_write_b32 v19, v18 offset:176
    s_cmp_eq_u32 s6, 3
    s_cbranch_scc0 L_a_hend
    s_mov_b32 s66, 160000
L_lw42:
    ds_read_b128 v[40:43], v2 offset:176
    s_waitcnt lgkmcnt(0)
    v_min_u32 v40, v40, v41
    v_min3_u32 v40, v40, v42, v43
    v_cmp_gt_u32 vcc, 1, v40
    s_cbranch_vccz L_lw42_ok
    s_sleep 2
    s_sub_u32 s66, s66, 1
    s_cmp_lg_u32 s66, 0
    s_cbranch_scc1 L_lw42
L_lw42_ok:
    s_add_u32 s65, s65, 8192
    buffer_store_dword v18, v17, s[40:43], s65 offen sc1
    s_mov_b32 s60, s69
    v_mov_b32 v21, v16
    s_add_u32 s60, s60, 8192
    s_mov_b32 s66, 20000
    s_sleep 16
L_a_ypoll:
    s_nop 0
    buffer_load_dwordx4 v[24:27], v21, s[40:43], s60 offen sc1
    s_waitcnt vmcnt(0)
    v_and_b32 v24, v24, v25
    v_and_b32 v26, v26, v27
    v_and_b32 v24, v24, v26
    v_cmp_ne_u32 vcc, 1, v24
    s_cbranch_vccz L_a_yok
    s_sleep 8
    s_sub_u32 s66, s66, 1
    s_cmp_lg_u32 s66, 0
    s_cbranch_scc1 L_a_ypoll
L_a_yok:
    s_mul_i32 s60, s5, 294912
    s_lshl_b32 s61, s4, 7
    s_add_u32 s60, s60, s61
    s_add_u32 s60, s60, 9961472
    v_lshrrev_b32 v20, 3, v0
    v_and_b32 v21, 7, v0
    v_lshlrev_b32_e64 v22, 12, v20
    v_lshl_add_u32 v22, v21, 4, v22
    v_lshrrev_b32_e64 v23, 1, v21
    v_mul_u32_u24 v23, 6144, v23
    v_lshl_add_u32 v23, v20, 5, v23
    v_and_b32_e64 v21, 1, v21
    v_lshl_add_u32 v23, v21, 4, v23
    v_add_u32 v23, 27648, v23
    buffer_load_dwordx4 v[40:43], v22, s[40:43], s60 offen
    s_add_u32 s60, s60, 32768
    buffer_load_dwordx4 v[44:47], v22, s[40:43], s60 offen
    s_add_u32 s60, s60, 32768
    buffer_load_dwordx4 v[48:51], v22, s[40:43], s60 offen
    s_add_u32 s60, s60, 32768
    buffer_load_dwordx4 v[52:55], v22, s[40:43], s60 offen
    s_add_u32 s60, s60, 32768
    buffer_load_dwordx4 v[56:59], v22, s[40:43], s60 offen
    s_add_u32 s60, s60, 32768
    buffer_load_dwordx4 v[60:63], v22, s[40:43], s60 offen
    s_add_u32 s60, s60, 32768
    buffer_load_dwordx4 v[64:67], v22, s[40:43], s60 offen
    s_add_u32 s60, s60, 32768
    buffer_load_dwordx4 v[68:71], v22, s[40:43], s60 offen
    s_add_u32 s60, s60, 32768
    buffer_load_dwordx4 v[72:75], v22, s[40:43], s60 offen
    s_add_u32 s60, s60, 32768
    s_mov_b32 s66, 160000
L_lw43:
    ds_read_b128 v[24:27], v2 offset:256
    s_waitcnt lgkmcnt(0)
    v_min_u32 v24, v24, v25
    v_min3_u32 v24, v24, v26, v27
    v_cmp_gt_u32 vcc, 1, v24
    s_cbranch_vccz L_lw43_ok
    s_sleep 4
    s_sub_u32 s66, s66, 1
    s_cmp_lg_u32 s66, 0
    s_cbranch_scc1 L_lw43
L_lw43_ok:
    s_waitcnt vmcnt(0)
    s_nop 0
    ds_write_b128 v23, v[40:43] offset:0
    ds_write_b128 v23, v[44:47] offset:256
    ds_write_b128 v23, v[48:51] offset:512
    ds_write_b128 v23, v[52:55] offset:768
    ds_write_b128 v23, v[56:59] offset:1024
    ds_write_b128 v23, v[60:63] offset:1280
    ds_write_b128 v23, v[64:67] offset:1536
    ds_write_b128 v23, v[68:71] offset:1792
    ds_write_b128 v23, v[72:75] offset:2048
    s_waitcnt lgkmcnt(0)
    s_nop 0
    ds_write_b32 v2, v18 offset:432
L_a_hend:
L_a_exit:
    s_endpgm
.section .rodata,"a"
.p2align 6
.amdhsa_kernel gated_mix__grouped_kv_mqa__ssm_conv_h3__prompt_kernel
  .amdhsa_next_free_vgpr 168
  .amdhsa_next_free_sgpr 102
  .amdhsa_accum_offset 168
  .amdhsa_group_segment_fixed_size 0
  .amdhsa_kernarg_size 120
  .amdhsa_user_sgpr_count 2
  .amdhsa_user_sgpr_kernarg_segment_ptr 1
  .amdhsa_system_sgpr_workgroup_id_x 1
.end_amdhsa_kernel
```
